```python
import torch

def _softmax(x, axis=-1):
    return torch.softmax(x, dim=axis)
def _gelu(x):
    return torch.nn.functional.gelu(x, approximate="tanh")
def _silu(x):
    return torch.nn.functional.silu(x)
def _sigmoid(x):
    return torch.sigmoid(x)
def _layernorm(x, axis=-1, eps=1e-5):
    m = x.mean(dim=axis, keepdim=True)
    v = x.var(dim=axis, keepdim=True, unbiased=False)
    return (x - m) / torch.sqrt(v + eps)
def _scatter_add(tgt, idx, src, axis=0):
    return tgt.clone().index_add_(axis, idx, src)
def _segment_sum(src, seg, n):
    out = torch.zeros((n,) + src.shape[1:], dtype=src.dtype)
    return out.index_add_(0, seg, src)
def _pad(x, pw):
    flat = tuple(v for pair in reversed(pw) for v in pair)
    return torch.nn.functional.pad(x, flat)

kernel_name = 'parallel_sum__sliding_block_cached__glu_gated_glu__decode'

def setup_inputs():

    _w = (lambda a: (lambda t: t.to(torch.bfloat16) if t.is_floating_point() else t)(torch.as_tensor(a)))
    def _A_setup():
        B, Sq, D = 1, 1, 448
        Hq, Hkv, Sk, Dh = 16, 8, 65536, 256
        assert Hq % Hkv == 0, (Hq, Hkv)
        return {
            "x": _w((lambda *s: torch.randn(*s, dtype=torch.bfloat16) * 0.05)(B, Sq, D)),
            "k_cache": _w((lambda *s: torch.randn(*s, dtype=torch.bfloat16) * 3.2)(B, Hkv, Sk, Dh)),
            "v_cache": _w((lambda *s: torch.randn(*s, dtype=torch.bfloat16) * 1.6)(B, Hkv, Sk, Dh)),
            "wq": _w((lambda *s: torch.randn(*s, dtype=torch.bfloat16) * 3.2)(D, Hq * Dh) * (D ** -0.5)),
            "wo": _w((lambda *s: torch.randn(*s, dtype=torch.bfloat16) * 1.6)(Hq * Dh, D) * ((Hq * Dh) ** -0.5)),
        }
    _A_in = _A_setup()

    def _B_setup():
        B, S, D, F = 1, 1, 448, 1792
        return {
            "x": _w((lambda *s: torch.randn(*s, dtype=torch.bfloat16) * 0.05)(B, S, D)),
            "w_gate": _w((lambda *s: torch.randn(*s, dtype=torch.bfloat16) * 0.1)(D, F)),
            "w_up": _w((lambda *s: torch.randn(*s, dtype=torch.bfloat16) * 0.05)(D, F)),
            "w_down": _w((lambda *s: torch.randn(*s, dtype=torch.bfloat16) * 0.05)(F, D)),
        }
    _B_in = _B_setup()

    return {
        "A_x": _A_in["x"],
        "A_k_cache": _A_in["k_cache"],
        "A_v_cache": _A_in["v_cache"],
        "A_wq": _A_in["wq"],
        "A_wo": _A_in["wo"],
        "B_x": _B_in["x"],
        "B_w_gate": _B_in["w_gate"],
        "B_w_up": _B_in["w_up"],
        "B_w_down": _B_in["w_down"],
    }

def reference(A_x, A_k_cache, A_v_cache, A_wq, A_wo, B_x, B_w_gate, B_w_up, B_w_down):
    def _A_ref(x, k_cache, v_cache, wq, wo):
        B, Sq, D = x.shape
        Hq, Dh = 16, 256
        Hkv, Sk = k_cache.shape[1], k_cache.shape[2]
        W = min(4096, max(256, Sk // 4))
        rep = Hq // Hkv
        q = (lambda x, *d: x.permute(*d))((x @ wq).reshape(B, Sq, Hq, Dh), 0, 2, 1, 3)
        k = (lambda x, n, axis: torch.repeat_interleave(x, n, dim=axis))(k_cache[:, :, Sk - W:, :], rep, axis=1)
        v = (lambda x, n, axis: torch.repeat_interleave(x, n, dim=axis))(v_cache[:, :, Sk - W:, :], rep, axis=1)
        scores = torch.einsum("bhqd,bhkd->bhqk", q, k) * (Dh ** -0.5)
        p = _softmax(scores, axis=-1)
        o = torch.einsum("bhqk,bhkd->bhqd", p, v)
        return (lambda x, *d: x.permute(*d))(o, 0, 2, 1, 3).reshape(B, Sq, Hq * Dh) @ wo

    def _B_ref(x, w_gate, w_up, w_down):
        g = torch.einsum("bsd,df->bsf", x, w_gate)
        u = torch.einsum("bsd,df->bsf", x, w_up)
        h = _sigmoid(g) * u
        return torch.einsum("bsf,fd->bsd", h, w_down)

    x = A_x
    xn = _layernorm(x, axis=-1)
    return x + _A_ref(xn, A_k_cache, A_v_cache, A_wq, A_wo) + _B_ref(xn, B_w_gate, B_w_up, B_w_down)
```

```asm
; @launch kernel=k1_kernel grid=(120,1,1) block=(256,1,1) lds=16384
; @launch kernel=k2_kernel grid=(256,1,1) block=(256,1,1) lds=20480
; @launch kernel=k3_kernel grid=(92,1,1) block=(448,1,1) lds=20480
.amdgcn_target "amdgcn-amd-amdhsa--gfx950"
.text
.globl k1_kernel
.p2align 8
.type k1_kernel,@function
k1_kernel:
    s_cmp_ge_u32 s2, 120
    s_cbranch_scc1 K1_END
    s_load_dwordx2 s[4:5], s[0:1], 0
    s_load_dwordx2 s[6:7], s[0:1], 24
    s_load_dwordx2 s[8:9], s[0:1], 48
    s_load_dwordx2 s[10:11], s[0:1], 56
    s_load_dwordx2 s[12:13], s[0:1], 88
    s_waitcnt lgkmcnt(0)
    s_cmp_lt_u32 s2, 64
    s_cbranch_scc0 K1_NOTQ
    s_lshl_b32 s21, s2, 6
    s_movk_i32 s22, 8192
    s_mov_b64 s[24:25], s[6:7]
    s_lshl_b32 s26, s21, 1
    s_add_u32 s26, s26, 0
    s_mov_b32 s20, 0
    s_branch K1_SEL
K1_NOTQ:
    s_cmp_lt_u32 s2, 92
    s_cbranch_scc0 K1_UP
    s_sub_u32 s21, s2, 64
    s_lshl_b32 s21, s21, 6
    s_movk_i32 s22, 3584
    s_mov_b64 s[24:25], s[8:9]
    s_lshl_b32 s26, s21, 2
    s_add_u32 s26, s26, 8192
    s_mov_b32 s20, 1
    s_branch K1_SEL
K1_UP:
    s_sub_u32 s21, s2, 92
    s_lshl_b32 s21, s21, 6
    s_movk_i32 s22, 3584
    s_mov_b64 s[24:25], s[10:11]
    s_lshl_b32 s26, s21, 2
    s_add_u32 s26, s26, 16384
    s_mov_b32 s20, 1
K1_SEL:
    s_lshl_b32 s27, s21, 1
    s_add_u32 s28, s24, s27
    s_addc_u32 s29, s25, 0
    s_and_b32 s29, s29, 0xffff
    s_mul_i32 s30, s22, 448
    s_sub_u32 s30, s30, s27
    s_mov_b32 s31, 0x00020000
    s_mov_b32 s32, s4
    s_and_b32 s33, s5, 0xffff
    s_movk_i32 s34, 896
    s_mov_b32 s35, 0x00020000
    s_mov_b32 s36, s12
    s_and_b32 s37, s13, 0xffff
    s_mov_b32 s38, 0x100000
    s_mov_b32 s39, 0x00020000
    v_and_b32 v1, 63, v0
    v_lshrrev_b32 v2, 6, v0
    v_lshrrev_b32 v3, 3, v1
    v_and_b32 v4, 7, v1
    v_mul_u32_u24 v5, 112, v2
    v_add_u32 v5, v5, v3
    v_mul_lo_u32 v6, v5, s22
    v_lshl_add_u32 v6, v4, 4, v6
    s_lshl_b32 s40, s22, 3
    s_mov_b32 s41, 0
    buffer_load_dwordx4 v[64:67], v6, s[28:31], s41 offen sc1 nt
    s_add_u32 s41, s41, s40
    buffer_load_dwordx4 v[68:71], v6, s[28:31], s41 offen sc1 nt
    s_add_u32 s41, s41, s40
    buffer_load_dwordx4 v[72:75], v6, s[28:31], s41 offen sc1 nt
    s_add_u32 s41, s41, s40
    buffer_load_dwordx4 v[76:79], v6, s[28:31], s41 offen sc1 nt
    s_add_u32 s41, s41, s40
    buffer_load_dwordx4 v[80:83], v6, s[28:31], s41 offen sc1 nt
    s_add_u32 s41, s41, s40
    buffer_load_dwordx4 v[84:87], v6, s[28:31], s41 offen sc1 nt
    s_add_u32 s41, s41, s40
    buffer_load_dwordx4 v[88:91], v6, s[28:31], s41 offen sc1 nt
    s_add_u32 s41, s41, s40
    buffer_load_dwordx4 v[92:95], v6, s[28:31], s41 offen sc1 nt
    s_add_u32 s41, s41, s40
    buffer_load_dwordx4 v[96:99], v6, s[28:31], s41 offen sc1 nt
    s_add_u32 s41, s41, s40
    buffer_load_dwordx4 v[100:103], v6, s[28:31], s41 offen sc1 nt
    s_add_u32 s41, s41, s40
    buffer_load_dwordx4 v[104:107], v6, s[28:31], s41 offen sc1 nt
    s_add_u32 s41, s41, s40
    buffer_load_dwordx4 v[108:111], v6, s[28:31], s41 offen sc1 nt
    s_add_u32 s41, s41, s40
    buffer_load_dwordx4 v[112:115], v6, s[28:31], s41 offen sc1 nt
    s_add_u32 s41, s41, s40
    buffer_load_dwordx4 v[116:119], v6, s[28:31], s41 offen sc1 nt
    s_add_u32 s41, s41, s40
    v_lshlrev_b32 v7, 4, v1
    buffer_load_dwordx4 v[8:11], v7, s[32:35], 0 offen
    v_xor_b32 v20, 1, v1
    v_lshlrev_b32 v20, 2, v20
    v_xor_b32 v21, 2, v1
    v_lshlrev_b32 v21, 2, v21
    v_xor_b32 v22, 4, v1
    v_lshlrev_b32 v22, 2, v22
    v_xor_b32 v23, 8, v1
    v_lshlrev_b32 v23, 2, v23
    v_xor_b32 v24, 16, v1
    v_lshlrev_b32 v24, 2, v24
    v_xor_b32 v25, 32, v1
    v_lshlrev_b32 v25, 2, v25
    s_waitcnt vmcnt(0)
    v_lshlrev_b32 v12, 16, v8
    v_and_b32 v13, 0xffff0000, v8
    v_lshlrev_b32 v14, 16, v9
    v_and_b32 v15, 0xffff0000, v9
    v_lshlrev_b32 v16, 16, v10
    v_and_b32 v17, 0xffff0000, v10
    v_lshlrev_b32 v18, 16, v11
    v_and_b32 v19, 0xffff0000, v11
    v_add_f32 v26, v12, v13
    v_add_f32 v26, v26, v14
    v_add_f32 v26, v26, v15
    v_add_f32 v26, v26, v16
    v_add_f32 v26, v26, v17
    v_add_f32 v26, v26, v18
    v_add_f32 v26, v26, v19
    ds_bpermute_b32 v27, v20, v26
    s_waitcnt lgkmcnt(0)
    v_add_f32 v26, v26, v27
    ds_bpermute_b32 v27, v21, v26
    s_waitcnt lgkmcnt(0)
    v_add_f32 v26, v26, v27
    ds_bpermute_b32 v27, v22, v26
    s_waitcnt lgkmcnt(0)
    v_add_f32 v26, v26, v27
    ds_bpermute_b32 v27, v23, v26
    s_waitcnt lgkmcnt(0)
    v_add_f32 v26, v26, v27
    ds_bpermute_b32 v27, v24, v26
    s_waitcnt lgkmcnt(0)
    v_add_f32 v26, v26, v27
    ds_bpermute_b32 v27, v25, v26
    s_waitcnt lgkmcnt(0)
    v_add_f32 v26, v26, v27
    v_mul_f32 v26, 0x3b124925, v26
    v_mov_b32 v28, 0
    v_sub_f32 v29, v12, v26
    v_fmac_f32 v28, v29, v29
    v_sub_f32 v29, v13, v26
    v_fmac_f32 v28, v29, v29
    v_sub_f32 v29, v14, v26
    v_fmac_f32 v28, v29, v29
    v_sub_f32 v29, v15, v26
    v_fmac_f32 v28, v29, v29
    v_sub_f32 v29, v16, v26
    v_fmac_f32 v28, v29, v29
    v_sub_f32 v29, v17, v26
    v_fmac_f32 v28, v29, v29
    v_sub_f32 v29, v18, v26
    v_fmac_f32 v28, v29, v29
    v_sub_f32 v29, v19, v26
    v_fmac_f32 v28, v29, v29
    v_cmp_gt_u32 vcc, 56, v1
    s_nop 1
    v_cndmask_b32 v28, 0, v28, vcc
    ds_bpermute_b32 v27, v20, v28
    s_waitcnt lgkmcnt(0)
    v_add_f32 v28, v28, v27
    ds_bpermute_b32 v27, v21, v28
    s_waitcnt lgkmcnt(0)
    v_add_f32 v28, v28, v27
    ds_bpermute_b32 v27, v22, v28
    s_waitcnt lgkmcnt(0)
    v_add_f32 v28, v28, v27
    ds_bpermute_b32 v27, v23, v28
    s_waitcnt lgkmcnt(0)
    v_add_f32 v28, v28, v27
    ds_bpermute_b32 v27, v24, v28
    s_waitcnt lgkmcnt(0)
    v_add_f32 v28, v28, v27
    ds_bpermute_b32 v27, v25, v28
    s_waitcnt lgkmcnt(0)
    v_add_f32 v28, v28, v27
    v_mul_f32 v28, 0x3b124925, v28
    v_cvt_pk_bf16_f32 v29, v26, v26
    v_lshlrev_b32 v26, 16, v29
    v_cvt_pk_bf16_f32 v29, v28, v28
    v_lshlrev_b32 v28, 16, v29
    v_add_f32 v28, 0x3727c5ac, v28
    v_cvt_pk_bf16_f32 v29, v28, v28
    v_lshlrev_b32 v28, 16, v29
    v_sqrt_f32 v28, v28
    s_nop 0
    v_cvt_pk_bf16_f32 v29, v28, v28
    v_lshlrev_b32 v28, 16, v29
    v_rcp_f32 v28, v28
    s_nop 0
    v_sub_f32 v12, v12, v26
    v_cvt_pk_bf16_f32 v29, v12, v12
    v_lshlrev_b32 v12, 16, v29
    v_mul_f32 v12, v12, v28
    v_cvt_pk_bf16_f32 v29, v12, v12
    v_lshlrev_b32 v12, 16, v29
    v_sub_f32 v13, v13, v26
    v_cvt_pk_bf16_f32 v29, v13, v13
    v_lshlrev_b32 v13, 16, v29
    v_mul_f32 v13, v13, v28
    v_cvt_pk_bf16_f32 v29, v13, v13
    v_lshlrev_b32 v13, 16, v29
    v_sub_f32 v14, v14, v26
    v_cvt_pk_bf16_f32 v29, v14, v14
    v_lshlrev_b32 v14, 16, v29
    v_mul_f32 v14, v14, v28
    v_cvt_pk_bf16_f32 v29, v14, v14
    v_lshlrev_b32 v14, 16, v29
    v_sub_f32 v15, v15, v26
    v_cvt_pk_bf16_f32 v29, v15, v15
    v_lshlrev_b32 v15, 16, v29
    v_mul_f32 v15, v15, v28
    v_cvt_pk_bf16_f32 v29, v15, v15
    v_lshlrev_b32 v15, 16, v29
    v_sub_f32 v16, v16, v26
    v_cvt_pk_bf16_f32 v29, v16, v16
    v_lshlrev_b32 v16, 16, v29
    v_mul_f32 v16, v16, v28
    v_cvt_pk_bf16_f32 v29, v16, v16
    v_lshlrev_b32 v16, 16, v29
    v_sub_f32 v17, v17, v26
    v_cvt_pk_bf16_f32 v29, v17, v17
    v_lshlrev_b32 v17, 16, v29
    v_mul_f32 v17, v17, v28
    v_cvt_pk_bf16_f32 v29, v17, v17
    v_lshlrev_b32 v17, 16, v29
    v_sub_f32 v18, v18, v26
    v_cvt_pk_bf16_f32 v29, v18, v18
    v_lshlrev_b32 v18, 16, v29
    v_mul_f32 v18, v18, v28
    v_cvt_pk_bf16_f32 v29, v18, v18
    v_lshlrev_b32 v18, 16, v29
    v_sub_f32 v19, v19, v26
    v_cvt_pk_bf16_f32 v29, v19, v19
    v_lshlrev_b32 v19, 16, v29
    v_mul_f32 v19, v19, v28
    v_cvt_pk_bf16_f32 v29, v19, v19
    v_lshlrev_b32 v19, 16, v29
    v_mul_u32_u24 v30, 1792, v2
    v_lshl_add_u32 v31, v1, 5, v30
    v_cmp_gt_u32 vcc, 56, v1
    s_and_saveexec_b64 s[42:43], vcc
    ds_write_b128 v31, v[12:15]
    ds_write_b128 v31, v[16:19] offset:16
    s_mov_b64 exec, s[42:43]
    s_waitcnt lgkmcnt(0)
    v_lshl_add_u32 v31, v5, 2, v30
    ds_read_b32 v32, v31 offset:0
    ds_read_b32 v33, v31 offset:32
    ds_read_b32 v34, v31 offset:64
    ds_read_b32 v35, v31 offset:96
    ds_read_b32 v36, v31 offset:128
    ds_read_b32 v37, v31 offset:160
    ds_read_b32 v38, v31 offset:192
    ds_read_b32 v39, v31 offset:224
    ds_read_b32 v40, v31 offset:256
    ds_read_b32 v41, v31 offset:288
    ds_read_b32 v42, v31 offset:320
    ds_read_b32 v43, v31 offset:352
    ds_read_b32 v44, v31 offset:384
    ds_read_b32 v45, v31 offset:416
    v_mov_b32 v48, 0
    v_mov_b32 v49, 0
    v_mov_b32 v50, 0
    v_mov_b32 v51, 0
    v_mov_b32 v52, 0
    v_mov_b32 v53, 0
    v_mov_b32 v54, 0
    v_mov_b32 v55, 0
    s_waitcnt lgkmcnt(0)
    v_lshlrev_b32 v56, 16, v64
    v_and_b32 v57, 0xffff0000, v64
    v_fmac_f32 v48, v32, v56
    v_fmac_f32 v49, v32, v57
    v_lshlrev_b32 v56, 16, v65
    v_and_b32 v57, 0xffff0000, v65
    v_fmac_f32 v50, v32, v56
    v_fmac_f32 v51, v32, v57
    v_lshlrev_b32 v56, 16, v66
    v_and_b32 v57, 0xffff0000, v66
    v_fmac_f32 v52, v32, v56
    v_fmac_f32 v53, v32, v57
    v_lshlrev_b32 v56, 16, v67
    v_and_b32 v57, 0xffff0000, v67
    v_fmac_f32 v54, v32, v56
    v_fmac_f32 v55, v32, v57
    v_lshlrev_b32 v56, 16, v68
    v_and_b32 v57, 0xffff0000, v68
    v_fmac_f32 v48, v33, v56
    v_fmac_f32 v49, v33, v57
    v_lshlrev_b32 v56, 16, v69
    v_and_b32 v57, 0xffff0000, v69
    v_fmac_f32 v50, v33, v56
    v_fmac_f32 v51, v33, v57
    v_lshlrev_b32 v56, 16, v70
    v_and_b32 v57, 0xffff0000, v70
    v_fmac_f32 v52, v33, v56
    v_fmac_f32 v53, v33, v57
    v_lshlrev_b32 v56, 16, v71
    v_and_b32 v57, 0xffff0000, v71
    v_fmac_f32 v54, v33, v56
    v_fmac_f32 v55, v33, v57
    v_lshlrev_b32 v56, 16, v72
    v_and_b32 v57, 0xffff0000, v72
    v_fmac_f32 v48, v34, v56
    v_fmac_f32 v49, v34, v57
    v_lshlrev_b32 v56, 16, v73
    v_and_b32 v57, 0xffff0000, v73
    v_fmac_f32 v50, v34, v56
    v_fmac_f32 v51, v34, v57
    v_lshlrev_b32 v56, 16, v74
    v_and_b32 v57, 0xffff0000, v74
    v_fmac_f32 v52, v34, v56
    v_fmac_f32 v53, v34, v57
    v_lshlrev_b32 v56, 16, v75
    v_and_b32 v57, 0xffff0000, v75
    v_fmac_f32 v54, v34, v56
    v_fmac_f32 v55, v34, v57
    v_lshlrev_b32 v56, 16, v76
    v_and_b32 v57, 0xffff0000, v76
    v_fmac_f32 v48, v35, v56
    v_fmac_f32 v49, v35, v57
    v_lshlrev_b32 v56, 16, v77
    v_and_b32 v57, 0xffff0000, v77
    v_fmac_f32 v50, v35, v56
    v_fmac_f32 v51, v35, v57
    v_lshlrev_b32 v56, 16, v78
    v_and_b32 v57, 0xffff0000, v78
    v_fmac_f32 v52, v35, v56
    v_fmac_f32 v53, v35, v57
    v_lshlrev_b32 v56, 16, v79
    v_and_b32 v57, 0xffff0000, v79
    v_fmac_f32 v54, v35, v56
    v_fmac_f32 v55, v35, v57
    v_lshlrev_b32 v56, 16, v80
    v_and_b32 v57, 0xffff0000, v80
    v_fmac_f32 v48, v36, v56
    v_fmac_f32 v49, v36, v57
    v_lshlrev_b32 v56, 16, v81
    v_and_b32 v57, 0xffff0000, v81
    v_fmac_f32 v50, v36, v56
    v_fmac_f32 v51, v36, v57
    v_lshlrev_b32 v56, 16, v82
    v_and_b32 v57, 0xffff0000, v82
    v_fmac_f32 v52, v36, v56
    v_fmac_f32 v53, v36, v57
    v_lshlrev_b32 v56, 16, v83
    v_and_b32 v57, 0xffff0000, v83
    v_fmac_f32 v54, v36, v56
    v_fmac_f32 v55, v36, v57
    v_lshlrev_b32 v56, 16, v84
    v_and_b32 v57, 0xffff0000, v84
    v_fmac_f32 v48, v37, v56
    v_fmac_f32 v49, v37, v57
    v_lshlrev_b32 v56, 16, v85
    v_and_b32 v57, 0xffff0000, v85
    v_fmac_f32 v50, v37, v56
    v_fmac_f32 v51, v37, v57
    v_lshlrev_b32 v56, 16, v86
    v_and_b32 v57, 0xffff0000, v86
    v_fmac_f32 v52, v37, v56
    v_fmac_f32 v53, v37, v57
    v_lshlrev_b32 v56, 16, v87
    v_and_b32 v57, 0xffff0000, v87
    v_fmac_f32 v54, v37, v56
    v_fmac_f32 v55, v37, v57
    v_lshlrev_b32 v56, 16, v88
    v_and_b32 v57, 0xffff0000, v88
    v_fmac_f32 v48, v38, v56
    v_fmac_f32 v49, v38, v57
    v_lshlrev_b32 v56, 16, v89
    v_and_b32 v57, 0xffff0000, v89
    v_fmac_f32 v50, v38, v56
    v_fmac_f32 v51, v38, v57
    v_lshlrev_b32 v56, 16, v90
    v_and_b32 v57, 0xffff0000, v90
    v_fmac_f32 v52, v38, v56
    v_fmac_f32 v53, v38, v57
    v_lshlrev_b32 v56, 16, v91
    v_and_b32 v57, 0xffff0000, v91
    v_fmac_f32 v54, v38, v56
    v_fmac_f32 v55, v38, v57
    v_lshlrev_b32 v56, 16, v92
    v_and_b32 v57, 0xffff0000, v92
    v_fmac_f32 v48, v39, v56
    v_fmac_f32 v49, v39, v57
    v_lshlrev_b32 v56, 16, v93
    v_and_b32 v57, 0xffff0000, v93
    v_fmac_f32 v50, v39, v56
    v_fmac_f32 v51, v39, v57
    v_lshlrev_b32 v56, 16, v94
    v_and_b32 v57, 0xffff0000, v94
    v_fmac_f32 v52, v39, v56
    v_fmac_f32 v53, v39, v57
    v_lshlrev_b32 v56, 16, v95
    v_and_b32 v57, 0xffff0000, v95
    v_fmac_f32 v54, v39, v56
    v_fmac_f32 v55, v39, v57
    v_lshlrev_b32 v56, 16, v96
    v_and_b32 v57, 0xffff0000, v96
    v_fmac_f32 v48, v40, v56
    v_fmac_f32 v49, v40, v57
    v_lshlrev_b32 v56, 16, v97
    v_and_b32 v57, 0xffff0000, v97
    v_fmac_f32 v50, v40, v56
    v_fmac_f32 v51, v40, v57
    v_lshlrev_b32 v56, 16, v98
    v_and_b32 v57, 0xffff0000, v98
    v_fmac_f32 v52, v40, v56
    v_fmac_f32 v53, v40, v57
    v_lshlrev_b32 v56, 16, v99
    v_and_b32 v57, 0xffff0000, v99
    v_fmac_f32 v54, v40, v56
    v_fmac_f32 v55, v40, v57
    v_lshlrev_b32 v56, 16, v100
    v_and_b32 v57, 0xffff0000, v100
    v_fmac_f32 v48, v41, v56
    v_fmac_f32 v49, v41, v57
    v_lshlrev_b32 v56, 16, v101
    v_and_b32 v57, 0xffff0000, v101
    v_fmac_f32 v50, v41, v56
    v_fmac_f32 v51, v41, v57
    v_lshlrev_b32 v56, 16, v102
    v_and_b32 v57, 0xffff0000, v102
    v_fmac_f32 v52, v41, v56
    v_fmac_f32 v53, v41, v57
    v_lshlrev_b32 v56, 16, v103
    v_and_b32 v57, 0xffff0000, v103
    v_fmac_f32 v54, v41, v56
    v_fmac_f32 v55, v41, v57
    v_lshlrev_b32 v56, 16, v104
    v_and_b32 v57, 0xffff0000, v104
    v_fmac_f32 v48, v42, v56
    v_fmac_f32 v49, v42, v57
    v_lshlrev_b32 v56, 16, v105
    v_and_b32 v57, 0xffff0000, v105
    v_fmac_f32 v50, v42, v56
    v_fmac_f32 v51, v42, v57
    v_lshlrev_b32 v56, 16, v106
    v_and_b32 v57, 0xffff0000, v106
    v_fmac_f32 v52, v42, v56
    v_fmac_f32 v53, v42, v57
    v_lshlrev_b32 v56, 16, v107
    v_and_b32 v57, 0xffff0000, v107
    v_fmac_f32 v54, v42, v56
    v_fmac_f32 v55, v42, v57
    v_lshlrev_b32 v56, 16, v108
    v_and_b32 v57, 0xffff0000, v108
    v_fmac_f32 v48, v43, v56
    v_fmac_f32 v49, v43, v57
    v_lshlrev_b32 v56, 16, v109
    v_and_b32 v57, 0xffff0000, v109
    v_fmac_f32 v50, v43, v56
    v_fmac_f32 v51, v43, v57
    v_lshlrev_b32 v56, 16, v110
    v_and_b32 v57, 0xffff0000, v110
    v_fmac_f32 v52, v43, v56
    v_fmac_f32 v53, v43, v57
    v_lshlrev_b32 v56, 16, v111
    v_and_b32 v57, 0xffff0000, v111
    v_fmac_f32 v54, v43, v56
    v_fmac_f32 v55, v43, v57
    v_lshlrev_b32 v56, 16, v112
    v_and_b32 v57, 0xffff0000, v112
    v_fmac_f32 v48, v44, v56
    v_fmac_f32 v49, v44, v57
    v_lshlrev_b32 v56, 16, v113
    v_and_b32 v57, 0xffff0000, v113
    v_fmac_f32 v50, v44, v56
    v_fmac_f32 v51, v44, v57
    v_lshlrev_b32 v56, 16, v114
    v_and_b32 v57, 0xffff0000, v114
    v_fmac_f32 v52, v44, v56
    v_fmac_f32 v53, v44, v57
    v_lshlrev_b32 v56, 16, v115
    v_and_b32 v57, 0xffff0000, v115
    v_fmac_f32 v54, v44, v56
    v_fmac_f32 v55, v44, v57
    v_lshlrev_b32 v56, 16, v116
    v_and_b32 v57, 0xffff0000, v116
    v_fmac_f32 v48, v45, v56
    v_fmac_f32 v49, v45, v57
    v_lshlrev_b32 v56, 16, v117
    v_and_b32 v57, 0xffff0000, v117
    v_fmac_f32 v50, v45, v56
    v_fmac_f32 v51, v45, v57
    v_lshlrev_b32 v56, 16, v118
    v_and_b32 v57, 0xffff0000, v118
    v_fmac_f32 v52, v45, v56
    v_fmac_f32 v53, v45, v57
    v_lshlrev_b32 v56, 16, v119
    v_and_b32 v57, 0xffff0000, v119
    v_fmac_f32 v54, v45, v56
    v_fmac_f32 v55, v45, v57
    s_barrier
    v_lshl_add_u32 v31, v2, 3, v3
    v_lshlrev_b32 v31, 8, v31
    v_lshl_add_u32 v31, v4, 5, v31
    ds_write_b128 v31, v[48:51] offset:8192
    ds_write_b128 v31, v[52:55] offset:8208
    s_waitcnt lgkmcnt(0)
    s_barrier
    v_cmp_gt_u32 vcc, 64, v0
    s_and_saveexec_b64 s[42:43], vcc
    s_cbranch_execz K1_END
    v_lshlrev_b32 v31, 2, v0
    ds_read_b32 v64, v31 offset:8192
    ds_read_b32 v65, v31 offset:8448
    ds_read_b32 v66, v31 offset:8704
    ds_read_b32 v67, v31 offset:8960
    ds_read_b32 v68, v31 offset:9216
    ds_read_b32 v69, v31 offset:9472
    ds_read_b32 v70, v31 offset:9728
    ds_read_b32 v71, v31 offset:9984
    ds_read_b32 v72, v31 offset:10240
    ds_read_b32 v73, v31 offset:10496
    ds_read_b32 v74, v31 offset:10752
    ds_read_b32 v75, v31 offset:11008
    ds_read_b32 v76, v31 offset:11264
    ds_read_b32 v77, v31 offset:11520
    ds_read_b32 v78, v31 offset:11776
    ds_read_b32 v79, v31 offset:12032
    ds_read_b32 v80, v31 offset:12288
    ds_read_b32 v81, v31 offset:12544
    ds_read_b32 v82, v31 offset:12800
    ds_read_b32 v83, v31 offset:13056
    ds_read_b32 v84, v31 offset:13312
    ds_read_b32 v85, v31 offset:13568
    ds_read_b32 v86, v31 offset:13824
    ds_read_b32 v87, v31 offset:14080
    ds_read_b32 v88, v31 offset:14336
    ds_read_b32 v89, v31 offset:14592
    ds_read_b32 v90, v31 offset:14848
    ds_read_b32 v91, v31 offset:15104
    ds_read_b32 v92, v31 offset:15360
    ds_read_b32 v93, v31 offset:15616
    ds_read_b32 v94, v31 offset:15872
    ds_read_b32 v95, v31 offset:16128
    s_waitcnt lgkmcnt(0)
    v_add_f32 v64, v64, v65
    v_add_f32 v64, v64, v66
    v_add_f32 v64, v64, v67
    v_add_f32 v64, v64, v68
    v_add_f32 v64, v64, v69
    v_add_f32 v64, v64, v70
    v_add_f32 v64, v64, v71
    v_add_f32 v64, v64, v72
    v_add_f32 v64, v64, v73
    v_add_f32 v64, v64, v74
    v_add_f32 v64, v64, v75
    v_add_f32 v64, v64, v76
    v_add_f32 v64, v64, v77
    v_add_f32 v64, v64, v78
    v_add_f32 v64, v64, v79
    v_add_f32 v64, v64, v80
    v_add_f32 v64, v64, v81
    v_add_f32 v64, v64, v82
    v_add_f32 v64, v64, v83
    v_add_f32 v64, v64, v84
    v_add_f32 v64, v64, v85
    v_add_f32 v64, v64, v86
    v_add_f32 v64, v64, v87
    v_add_f32 v64, v64, v88
    v_add_f32 v64, v64, v89
    v_add_f32 v64, v64, v90
    v_add_f32 v64, v64, v91
    v_add_f32 v64, v64, v92
    v_add_f32 v64, v64, v93
    v_add_f32 v64, v64, v94
    v_add_f32 v64, v64, v95
    v_cvt_pk_bf16_f32 v65, v64, v64
    s_cmp_eq_u32 s20, 0
    s_cbranch_scc0 K1_F32
    v_lshlrev_b32 v31, 1, v0
    buffer_store_short v65, v31, s[36:39], s26 offen
    s_branch K1_END
K1_F32:
    v_lshlrev_b32 v65, 16, v65
    v_lshlrev_b32 v31, 2, v0
    buffer_store_dword v65, v31, s[36:39], s26 offen
K1_END:
    s_endpgm
.globl k2_kernel
.p2align 8
.type k2_kernel,@function
k2_kernel:
    s_cmp_ge_u32 s2, 256
    s_cbranch_scc1 K2_END
    s_load_dwordx2 s[4:5], s[0:1], 8
    s_load_dwordx2 s[6:7], s[0:1], 16
    s_load_dwordx2 s[12:13], s[0:1], 88
    s_waitcnt lgkmcnt(0)
    s_lshr_b32 s14, s2, 5
    s_and_b32 s15, s2, 31
    s_lshl_b32 s20, s14, 25
    s_add_u32 s20, s20, 31457280
    s_add_u32 s16, s4, s20
    s_addc_u32 s17, s5, 0
    s_and_b32 s17, s17, 0xffff
    s_mov_b32 s18, 0x200000
    s_mov_b32 s19, 0x00020000
    s_add_u32 s24, s6, s20
    s_addc_u32 s25, s7, 0
    s_and_b32 s25, s25, 0xffff
    s_mov_b32 s26, 0x200000
    s_mov_b32 s27, 0x00020000
    s_lshl_b32 s20, s14, 10
    s_add_u32 s28, s12, s20
    s_addc_u32 s29, s13, 0
    s_and_b32 s29, s29, 0xffff
    s_movk_i32 s30, 1024
    s_mov_b32 s31, 0x00020000
    s_mov_b32 s32, s12
    s_and_b32 s33, s13, 0xffff
    s_mov_b32 s34, 0x100000
    s_mov_b32 s35, 0x00020000
    v_and_b32 v1, 63, v0
    v_lshrrev_b32 v2, 6, v0
    v_and_b32 v3, 15, v1
    v_lshrrev_b32 v4, 4, v1
    v_lshlrev_b32 v5, 9, v3
    v_lshl_add_u32 v5, v4, 4, v5
    buffer_load_dwordx4 v[8:11], v5, s[28:31], 0 offen offset:0
    buffer_load_dwordx4 v[12:15], v5, s[28:31], 0 offen offset:64
    buffer_load_dwordx4 v[16:19], v5, s[28:31], 0 offen offset:128
    buffer_load_dwordx4 v[20:23], v5, s[28:31], 0 offen offset:192
    buffer_load_dwordx4 v[24:27], v5, s[28:31], 0 offen offset:256
    buffer_load_dwordx4 v[28:31], v5, s[28:31], 0 offen offset:320
    buffer_load_dwordx4 v[32:35], v5, s[28:31], 0 offen offset:384
    buffer_load_dwordx4 v[36:39], v5, s[28:31], 0 offen offset:448
    s_lshl_b32 s20, s15, 16
    v_lshlrev_b32 v6, 14, v2
    v_add_u32 v6, v6, v5
    v_add_u32 v6, s20, v6
    s_movk_i32 s21, 8192
    buffer_load_dwordx4 v[40:43], v6, s[16:19], 0 offen offset:0 sc1 nt
    buffer_load_dwordx4 v[44:47], v6, s[16:19], 0 offen offset:64 sc1 nt
    buffer_load_dwordx4 v[48:51], v6, s[16:19], 0 offen offset:128 sc1 nt
    buffer_load_dwordx4 v[52:55], v6, s[16:19], 0 offen offset:192 sc1 nt
    buffer_load_dwordx4 v[56:59], v6, s[16:19], 0 offen offset:256 sc1 nt
    buffer_load_dwordx4 v[60:63], v6, s[16:19], 0 offen offset:320 sc1 nt
    buffer_load_dwordx4 v[64:67], v6, s[16:19], 0 offen offset:384 sc1 nt
    buffer_load_dwordx4 v[68:71], v6, s[16:19], 0 offen offset:448 sc1 nt
    buffer_load_dwordx4 v[72:75], v6, s[16:19], s21 offen offset:0 sc1 nt
    buffer_load_dwordx4 v[76:79], v6, s[16:19], s21 offen offset:64 sc1 nt
    buffer_load_dwordx4 v[80:83], v6, s[16:19], s21 offen offset:128 sc1 nt
    buffer_load_dwordx4 v[84:87], v6, s[16:19], s21 offen offset:192 sc1 nt
    buffer_load_dwordx4 v[88:91], v6, s[16:19], s21 offen offset:256 sc1 nt
    buffer_load_dwordx4 v[92:95], v6, s[16:19], s21 offen offset:320 sc1 nt
    buffer_load_dwordx4 v[96:99], v6, s[16:19], s21 offen offset:384 sc1 nt
    buffer_load_dwordx4 v[100:103], v6, s[16:19], s21 offen offset:448 sc1 nt
    v_lshrrev_b32 v7, 5, v1
    v_lshlrev_b32 v7, 9, v7
    v_and_b32 v192, 31, v1
    v_lshl_add_u32 v7, v192, 4, v7
    v_lshlrev_b32 v192, 14, v2
    v_add_u32 v7, v7, v192
    v_add_u32 v7, s20, v7
    s_mov_b32 s22, 0
    buffer_load_dwordx4 v[104:107], v7, s[24:27], s22 offen sc1 nt
    s_add_u32 s22, s22, 1024
    buffer_load_dwordx4 v[108:111], v7, s[24:27], s22 offen sc1 nt
    s_add_u32 s22, s22, 1024
    buffer_load_dwordx4 v[112:115], v7, s[24:27], s22 offen sc1 nt
    s_add_u32 s22, s22, 1024
    buffer_load_dwordx4 v[116:119], v7, s[24:27], s22 offen sc1 nt
    s_add_u32 s22, s22, 1024
    buffer_load_dwordx4 v[120:123], v7, s[24:27], s22 offen sc1 nt
    s_add_u32 s22, s22, 1024
    buffer_load_dwordx4 v[124:127], v7, s[24:27], s22 offen sc1 nt
    s_add_u32 s22, s22, 1024
    buffer_load_dwordx4 v[128:131], v7, s[24:27], s22 offen sc1 nt
    s_add_u32 s22, s22, 1024
    buffer_load_dwordx4 v[132:135], v7, s[24:27], s22 offen sc1 nt
    s_add_u32 s22, s22, 1024
    buffer_load_dwordx4 v[136:139], v7, s[24:27], s22 offen sc1 nt
    s_add_u32 s22, s22, 1024
    buffer_load_dwordx4 v[140:143], v7, s[24:27], s22 offen sc1 nt
    s_add_u32 s22, s22, 1024
    buffer_load_dwordx4 v[144:147], v7, s[24:27], s22 offen sc1 nt
    s_add_u32 s22, s22, 1024
    buffer_load_dwordx4 v[148:151], v7, s[24:27], s22 offen sc1 nt
    s_add_u32 s22, s22, 1024
    buffer_load_dwordx4 v[152:155], v7, s[24:27], s22 offen sc1 nt
    s_add_u32 s22, s22, 1024
    buffer_load_dwordx4 v[156:159], v7, s[24:27], s22 offen sc1 nt
    s_add_u32 s22, s22, 1024
    buffer_load_dwordx4 v[160:163], v7, s[24:27], s22 offen sc1 nt
    s_add_u32 s22, s22, 1024
    buffer_load_dwordx4 v[164:167], v7, s[24:27], s22 offen sc1 nt
    s_add_u32 s22, s22, 1024
    v_mov_b32 v168, 0
    v_mov_b32 v169, 0
    v_mov_b32 v170, 0
    v_mov_b32 v171, 0
    v_mov_b32 v172, 0
    v_mov_b32 v173, 0
    v_mov_b32 v174, 0
    v_mov_b32 v175, 0
    s_waitcnt vmcnt(16)
    v_mfma_f32_16x16x32_bf16 v[168:171], v[40:43], v[8:11], v[168:171]
    v_mfma_f32_16x16x32_bf16 v[168:171], v[44:47], v[12:15], v[168:171]
    v_mfma_f32_16x16x32_bf16 v[168:171], v[48:51], v[16:19], v[168:171]
    v_mfma_f32_16x16x32_bf16 v[168:171], v[52:55], v[20:23], v[168:171]
    v_mfma_f32_16x16x32_bf16 v[168:171], v[56:59], v[24:27], v[168:171]
    v_mfma_f32_16x16x32_bf16 v[168:171], v[60:63], v[28:31], v[168:171]
    v_mfma_f32_16x16x32_bf16 v[168:171], v[64:67], v[32:35], v[168:171]
    v_mfma_f32_16x16x32_bf16 v[168:171], v[68:71], v[36:39], v[168:171]
    v_mfma_f32_16x16x32_bf16 v[172:175], v[72:75], v[8:11], v[172:175]
    v_mfma_f32_16x16x32_bf16 v[172:175], v[76:79], v[12:15], v[172:175]
    v_mfma_f32_16x16x32_bf16 v[172:175], v[80:83], v[16:19], v[172:175]
    v_mfma_f32_16x16x32_bf16 v[172:175], v[84:87], v[20:23], v[172:175]
    v_mfma_f32_16x16x32_bf16 v[172:175], v[88:91], v[24:27], v[172:175]
    v_mfma_f32_16x16x32_bf16 v[172:175], v[92:95], v[28:31], v[172:175]
    v_mfma_f32_16x16x32_bf16 v[172:175], v[96:99], v[32:35], v[172:175]
    v_mfma_f32_16x16x32_bf16 v[172:175], v[100:103], v[36:39], v[172:175]
    s_nop 7
    s_nop 1
    v_mul_f32 v168, 0x3db8aa3b, v168
    v_mul_f32 v169, 0x3db8aa3b, v169
    v_mul_f32 v170, 0x3db8aa3b, v170
    v_mul_f32 v171, 0x3db8aa3b, v171
    v_mul_f32 v172, 0x3db8aa3b, v172
    v_mul_f32 v173, 0x3db8aa3b, v173
    v_mul_f32 v174, 0x3db8aa3b, v174
    v_mul_f32 v175, 0x3db8aa3b, v175
    v_max3_f32 v192, v168, v169, v170
    v_max3_f32 v192, v192, v171, v172
    v_max3_f32 v192, v192, v173, v174
    v_max_f32 v192, v192, v175
    v_xor_b32 v193, 16, v1
    v_lshlrev_b32 v193, 2, v193
    v_xor_b32 v194, 32, v1
    v_lshlrev_b32 v194, 2, v194
    ds_bpermute_b32 v195, v193, v192
    s_waitcnt lgkmcnt(0)
    v_max_f32 v192, v192, v195
    ds_bpermute_b32 v195, v194, v192
    s_waitcnt lgkmcnt(0)
    v_max_f32 v192, v192, v195
    v_lshlrev_b32 v195, 3, v2
    v_lshl_add_u32 v195, v1, 2, v195
    v_cmp_gt_u32 vcc, 2, v1
    s_and_saveexec_b64 s[40:41], vcc
    ds_write_b32 v195, v192
    s_mov_b64 exec, s[40:41]
    s_waitcnt lgkmcnt(0)
    s_barrier
    v_and_b32 v195, 1, v1
    v_lshlrev_b32 v195, 2, v195
    ds_read_b32 v196, v195
    ds_read_b32 v197, v195 offset:8
    ds_read_b32 v198, v195 offset:16
    ds_read_b32 v199, v195 offset:24
    s_waitcnt lgkmcnt(0)
    v_max3_f32 v192, v196, v197, v198
    v_max_f32 v192, v192, v199
    v_sub_f32 v168, v168, v192
    v_exp_f32 v168, v168
    v_sub_f32 v169, v169, v192
    v_exp_f32 v169, v169
    v_sub_f32 v170, v170, v192
    v_exp_f32 v170, v170
    v_sub_f32 v171, v171, v192
    v_exp_f32 v171, v171
    v_sub_f32 v172, v172, v192
    v_exp_f32 v172, v172
    v_sub_f32 v173, v173, v192
    v_exp_f32 v173, v173
    v_sub_f32 v174, v174, v192
    v_exp_f32 v174, v174
    v_sub_f32 v175, v175, v192
    v_exp_f32 v175, v175
    s_nop 0
    v_add_f32 v196, v168, v169
    v_add_f32 v196, v196, v170
    v_add_f32 v196, v196, v171
    v_add_f32 v196, v196, v172
    v_add_f32 v196, v196, v173
    v_add_f32 v196, v196, v174
    v_add_f32 v196, v196, v175
    v_lshlrev_b32 v195, 8, v2
    v_lshl_add_u32 v195, v4, 5, v195
    v_lshl_add_u32 v195, v3, 2, v195
    v_cmp_gt_u32 vcc, 2, v3
    s_and_saveexec_b64 s[40:41], vcc
    ds_write_b32 v195, v168 offset:64
    ds_write_b32 v195, v169 offset:72
    ds_write_b32 v195, v170 offset:80
    ds_write_b32 v195, v171 offset:88
    ds_write_b32 v195, v172 offset:192
    ds_write_b32 v195, v173 offset:200
    ds_write_b32 v195, v174 offset:208
    ds_write_b32 v195, v175 offset:216
    v_lshlrev_b32 v197, 5, v2
    v_lshl_add_u32 v197, v4, 3, v197
    v_lshl_add_u32 v197, v3, 2, v197
    ds_write_b32 v197, v196 offset:2048
    s_mov_b64 exec, s[40:41]
    s_waitcnt lgkmcnt(0)
    v_lshrrev_b32 v195, 5, v1
    v_lshlrev_b32 v195, 3, v195
    v_lshl_add_u32 v195, v2, 8, v195
    ds_read_b64 v[200:201], v195 offset:64
    ds_read_b64 v[202:203], v195 offset:80
    ds_read_b64 v[204:205], v195 offset:96
    ds_read_b64 v[206:207], v195 offset:112
    ds_read_b64 v[208:209], v195 offset:128
    ds_read_b64 v[210:211], v195 offset:144
    ds_read_b64 v[212:213], v195 offset:160
    ds_read_b64 v[214:215], v195 offset:176
    ds_read_b64 v[216:217], v195 offset:192
    ds_read_b64 v[218:219], v195 offset:208
    ds_read_b64 v[220:221], v195 offset:224
    ds_read_b64 v[222:223], v195 offset:240
    ds_read_b64 v[224:225], v195 offset:256
    ds_read_b64 v[226:227], v195 offset:272
    ds_read_b64 v[228:229], v195 offset:288
    ds_read_b64 v[230:231], v195 offset:304
    v_mov_b32 v176, 0
    v_mov_b32 v177, 0
    v_mov_b32 v178, 0
    v_mov_b32 v179, 0
    v_mov_b32 v180, 0
    v_mov_b32 v181, 0
    v_mov_b32 v182, 0
    v_mov_b32 v183, 0
    v_mov_b32 v184, 0
    v_mov_b32 v185, 0
    v_mov_b32 v186, 0
    v_mov_b32 v187, 0
    v_mov_b32 v188, 0
    v_mov_b32 v189, 0
    v_mov_b32 v190, 0
    v_mov_b32 v191, 0
    s_waitcnt lgkmcnt(0)
    s_waitcnt vmcnt(15)
    v_lshlrev_b32 v196, 16, v104
    v_and_b32 v197, 0xffff0000, v104
    v_fmac_f32 v176, v200, v196
    v_fmac_f32 v177, v200, v197
    v_fmac_f32 v184, v201, v196
    v_fmac_f32 v185, v201, v197
    v_lshlrev_b32 v196, 16, v105
    v_and_b32 v197, 0xffff0000, v105
    v_fmac_f32 v178, v200, v196
    v_fmac_f32 v179, v200, v197
    v_fmac_f32 v186, v201, v196
    v_fmac_f32 v187, v201, v197
    v_lshlrev_b32 v196, 16, v106
    v_and_b32 v197, 0xffff0000, v106
    v_fmac_f32 v180, v200, v196
    v_fmac_f32 v181, v200, v197
    v_fmac_f32 v188, v201, v196
    v_fmac_f32 v189, v201, v197
    v_lshlrev_b32 v196, 16, v107
    v_and_b32 v197, 0xffff0000, v107
    v_fmac_f32 v182, v200, v196
    v_fmac_f32 v183, v200, v197
    v_fmac_f32 v190, v201, v196
    v_fmac_f32 v191, v201, v197
    s_waitcnt vmcnt(14)
    v_lshlrev_b32 v196, 16, v108
    v_and_b32 v197, 0xffff0000, v108
    v_fmac_f32 v176, v202, v196
    v_fmac_f32 v177, v202, v197
    v_fmac_f32 v184, v203, v196
    v_fmac_f32 v185, v203, v197
    v_lshlrev_b32 v196, 16, v109
    v_and_b32 v197, 0xffff0000, v109
    v_fmac_f32 v178, v202, v196
    v_fmac_f32 v179, v202, v197
    v_fmac_f32 v186, v203, v196
    v_fmac_f32 v187, v203, v197
    v_lshlrev_b32 v196, 16, v110
    v_and_b32 v197, 0xffff0000, v110
    v_fmac_f32 v180, v202, v196
    v_fmac_f32 v181, v202, v197
    v_fmac_f32 v188, v203, v196
    v_fmac_f32 v189, v203, v197
    v_lshlrev_b32 v196, 16, v111
    v_and_b32 v197, 0xffff0000, v111
    v_fmac_f32 v182, v202, v196
    v_fmac_f32 v183, v202, v197
    v_fmac_f32 v190, v203, v196
    v_fmac_f32 v191, v203, v197
    s_waitcnt vmcnt(13)
    v_lshlrev_b32 v196, 16, v112
    v_and_b32 v197, 0xffff0000, v112
    v_fmac_f32 v176, v204, v196
    v_fmac_f32 v177, v204, v197
    v_fmac_f32 v184, v205, v196
    v_fmac_f32 v185, v205, v197
    v_lshlrev_b32 v196, 16, v113
    v_and_b32 v197, 0xffff0000, v113
    v_fmac_f32 v178, v204, v196
    v_fmac_f32 v179, v204, v197
    v_fmac_f32 v186, v205, v196
    v_fmac_f32 v187, v205, v197
    v_lshlrev_b32 v196, 16, v114
    v_and_b32 v197, 0xffff0000, v114
    v_fmac_f32 v180, v204, v196
    v_fmac_f32 v181, v204, v197
    v_fmac_f32 v188, v205, v196
    v_fmac_f32 v189, v205, v197
    v_lshlrev_b32 v196, 16, v115
    v_and_b32 v197, 0xffff0000, v115
    v_fmac_f32 v182, v204, v196
    v_fmac_f32 v183, v204, v197
    v_fmac_f32 v190, v205, v196
    v_fmac_f32 v191, v205, v197
    s_waitcnt vmcnt(12)
    v_lshlrev_b32 v196, 16, v116
    v_and_b32 v197, 0xffff0000, v116
    v_fmac_f32 v176, v206, v196
    v_fmac_f32 v177, v206, v197
    v_fmac_f32 v184, v207, v196
    v_fmac_f32 v185, v207, v197
    v_lshlrev_b32 v196, 16, v117
    v_and_b32 v197, 0xffff0000, v117
    v_fmac_f32 v178, v206, v196
    v_fmac_f32 v179, v206, v197
    v_fmac_f32 v186, v207, v196
    v_fmac_f32 v187, v207, v197
    v_lshlrev_b32 v196, 16, v118
    v_and_b32 v197, 0xffff0000, v118
    v_fmac_f32 v180, v206, v196
    v_fmac_f32 v181, v206, v197
    v_fmac_f32 v188, v207, v196
    v_fmac_f32 v189, v207, v197
    v_lshlrev_b32 v196, 16, v119
    v_and_b32 v197, 0xffff0000, v119
    v_fmac_f32 v182, v206, v196
    v_fmac_f32 v183, v206, v197
    v_fmac_f32 v190, v207, v196
    v_fmac_f32 v191, v207, v197
    s_waitcnt vmcnt(11)
    v_lshlrev_b32 v196, 16, v120
    v_and_b32 v197, 0xffff0000, v120
    v_fmac_f32 v176, v208, v196
    v_fmac_f32 v177, v208, v197
    v_fmac_f32 v184, v209, v196
    v_fmac_f32 v185, v209, v197
    v_lshlrev_b32 v196, 16, v121
    v_and_b32 v197, 0xffff0000, v121
    v_fmac_f32 v178, v208, v196
    v_fmac_f32 v179, v208, v197
    v_fmac_f32 v186, v209, v196
    v_fmac_f32 v187, v209, v197
    v_lshlrev_b32 v196, 16, v122
    v_and_b32 v197, 0xffff0000, v122
    v_fmac_f32 v180, v208, v196
    v_fmac_f32 v181, v208, v197
    v_fmac_f32 v188, v209, v196
    v_fmac_f32 v189, v209, v197
    v_lshlrev_b32 v196, 16, v123
    v_and_b32 v197, 0xffff0000, v123
    v_fmac_f32 v182, v208, v196
    v_fmac_f32 v183, v208, v197
    v_fmac_f32 v190, v209, v196
    v_fmac_f32 v191, v209, v197
    s_waitcnt vmcnt(10)
    v_lshlrev_b32 v196, 16, v124
    v_and_b32 v197, 0xffff0000, v124
    v_fmac_f32 v176, v210, v196
    v_fmac_f32 v177, v210, v197
    v_fmac_f32 v184, v211, v196
    v_fmac_f32 v185, v211, v197
    v_lshlrev_b32 v196, 16, v125
    v_and_b32 v197, 0xffff0000, v125
    v_fmac_f32 v178, v210, v196
    v_fmac_f32 v179, v210, v197
    v_fmac_f32 v186, v211, v196
    v_fmac_f32 v187, v211, v197
    v_lshlrev_b32 v196, 16, v126
    v_and_b32 v197, 0xffff0000, v126
    v_fmac_f32 v180, v210, v196
    v_fmac_f32 v181, v210, v197
    v_fmac_f32 v188, v211, v196
    v_fmac_f32 v189, v211, v197
    v_lshlrev_b32 v196, 16, v127
    v_and_b32 v197, 0xffff0000, v127
    v_fmac_f32 v182, v210, v196
    v_fmac_f32 v183, v210, v197
    v_fmac_f32 v190, v211, v196
    v_fmac_f32 v191, v211, v197
    s_waitcnt vmcnt(9)
    v_lshlrev_b32 v196, 16, v128
    v_and_b32 v197, 0xffff0000, v128
    v_fmac_f32 v176, v212, v196
    v_fmac_f32 v177, v212, v197
    v_fmac_f32 v184, v213, v196
    v_fmac_f32 v185, v213, v197
    v_lshlrev_b32 v196, 16, v129
    v_and_b32 v197, 0xffff0000, v129
    v_fmac_f32 v178, v212, v196
    v_fmac_f32 v179, v212, v197
    v_fmac_f32 v186, v213, v196
    v_fmac_f32 v187, v213, v197
    v_lshlrev_b32 v196, 16, v130
    v_and_b32 v197, 0xffff0000, v130
    v_fmac_f32 v180, v212, v196
    v_fmac_f32 v181, v212, v197
    v_fmac_f32 v188, v213, v196
    v_fmac_f32 v189, v213, v197
    v_lshlrev_b32 v196, 16, v131
    v_and_b32 v197, 0xffff0000, v131
    v_fmac_f32 v182, v212, v196
    v_fmac_f32 v183, v212, v197
    v_fmac_f32 v190, v213, v196
    v_fmac_f32 v191, v213, v197
    s_waitcnt vmcnt(8)
    v_lshlrev_b32 v196, 16, v132
    v_and_b32 v197, 0xffff0000, v132
    v_fmac_f32 v176, v214, v196
    v_fmac_f32 v177, v214, v197
    v_fmac_f32 v184, v215, v196
    v_fmac_f32 v185, v215, v197
    v_lshlrev_b32 v196, 16, v133
    v_and_b32 v197, 0xffff0000, v133
    v_fmac_f32 v178, v214, v196
    v_fmac_f32 v179, v214, v197
    v_fmac_f32 v186, v215, v196
    v_fmac_f32 v187, v215, v197
    v_lshlrev_b32 v196, 16, v134
    v_and_b32 v197, 0xffff0000, v134
    v_fmac_f32 v180, v214, v196
    v_fmac_f32 v181, v214, v197
    v_fmac_f32 v188, v215, v196
    v_fmac_f32 v189, v215, v197
    v_lshlrev_b32 v196, 16, v135
    v_and_b32 v197, 0xffff0000, v135
    v_fmac_f32 v182, v214, v196
    v_fmac_f32 v183, v214, v197
    v_fmac_f32 v190, v215, v196
    v_fmac_f32 v191, v215, v197
    s_waitcnt vmcnt(7)
    v_lshlrev_b32 v196, 16, v136
    v_and_b32 v197, 0xffff0000, v136
    v_fmac_f32 v176, v216, v196
    v_fmac_f32 v177, v216, v197
    v_fmac_f32 v184, v217, v196
    v_fmac_f32 v185, v217, v197
    v_lshlrev_b32 v196, 16, v137
    v_and_b32 v197, 0xffff0000, v137
    v_fmac_f32 v178, v216, v196
    v_fmac_f32 v179, v216, v197
    v_fmac_f32 v186, v217, v196
    v_fmac_f32 v187, v217, v197
    v_lshlrev_b32 v196, 16, v138
    v_and_b32 v197, 0xffff0000, v138
    v_fmac_f32 v180, v216, v196
    v_fmac_f32 v181, v216, v197
    v_fmac_f32 v188, v217, v196
    v_fmac_f32 v189, v217, v197
    v_lshlrev_b32 v196, 16, v139
    v_and_b32 v197, 0xffff0000, v139
    v_fmac_f32 v182, v216, v196
    v_fmac_f32 v183, v216, v197
    v_fmac_f32 v190, v217, v196
    v_fmac_f32 v191, v217, v197
    s_waitcnt vmcnt(6)
    v_lshlrev_b32 v196, 16, v140
    v_and_b32 v197, 0xffff0000, v140
    v_fmac_f32 v176, v218, v196
    v_fmac_f32 v177, v218, v197
    v_fmac_f32 v184, v219, v196
    v_fmac_f32 v185, v219, v197
    v_lshlrev_b32 v196, 16, v141
    v_and_b32 v197, 0xffff0000, v141
    v_fmac_f32 v178, v218, v196
    v_fmac_f32 v179, v218, v197
    v_fmac_f32 v186, v219, v196
    v_fmac_f32 v187, v219, v197
    v_lshlrev_b32 v196, 16, v142
    v_and_b32 v197, 0xffff0000, v142
    v_fmac_f32 v180, v218, v196
    v_fmac_f32 v181, v218, v197
    v_fmac_f32 v188, v219, v196
    v_fmac_f32 v189, v219, v197
    v_lshlrev_b32 v196, 16, v143
    v_and_b32 v197, 0xffff0000, v143
    v_fmac_f32 v182, v218, v196
    v_fmac_f32 v183, v218, v197
    v_fmac_f32 v190, v219, v196
    v_fmac_f32 v191, v219, v197
    s_waitcnt vmcnt(5)
    v_lshlrev_b32 v196, 16, v144
    v_and_b32 v197, 0xffff0000, v144
    v_fmac_f32 v176, v220, v196
    v_fmac_f32 v177, v220, v197
    v_fmac_f32 v184, v221, v196
    v_fmac_f32 v185, v221, v197
    v_lshlrev_b32 v196, 16, v145
    v_and_b32 v197, 0xffff0000, v145
    v_fmac_f32 v178, v220, v196
    v_fmac_f32 v179, v220, v197
    v_fmac_f32 v186, v221, v196
    v_fmac_f32 v187, v221, v197
    v_lshlrev_b32 v196, 16, v146
    v_and_b32 v197, 0xffff0000, v146
    v_fmac_f32 v180, v220, v196
    v_fmac_f32 v181, v220, v197
    v_fmac_f32 v188, v221, v196
    v_fmac_f32 v189, v221, v197
    v_lshlrev_b32 v196, 16, v147
    v_and_b32 v197, 0xffff0000, v147
    v_fmac_f32 v182, v220, v196
    v_fmac_f32 v183, v220, v197
    v_fmac_f32 v190, v221, v196
    v_fmac_f32 v191, v221, v197
    s_waitcnt vmcnt(4)
    v_lshlrev_b32 v196, 16, v148
    v_and_b32 v197, 0xffff0000, v148
    v_fmac_f32 v176, v222, v196
    v_fmac_f32 v177, v222, v197
    v_fmac_f32 v184, v223, v196
    v_fmac_f32 v185, v223, v197
    v_lshlrev_b32 v196, 16, v149
    v_and_b32 v197, 0xffff0000, v149
    v_fmac_f32 v178, v222, v196
    v_fmac_f32 v179, v222, v197
    v_fmac_f32 v186, v223, v196
    v_fmac_f32 v187, v223, v197
    v_lshlrev_b32 v196, 16, v150
    v_and_b32 v197, 0xffff0000, v150
    v_fmac_f32 v180, v222, v196
    v_fmac_f32 v181, v222, v197
    v_fmac_f32 v188, v223, v196
    v_fmac_f32 v189, v223, v197
    v_lshlrev_b32 v196, 16, v151
    v_and_b32 v197, 0xffff0000, v151
    v_fmac_f32 v182, v222, v196
    v_fmac_f32 v183, v222, v197
    v_fmac_f32 v190, v223, v196
    v_fmac_f32 v191, v223, v197
    s_waitcnt vmcnt(3)
    v_lshlrev_b32 v196, 16, v152
    v_and_b32 v197, 0xffff0000, v152
    v_fmac_f32 v176, v224, v196
    v_fmac_f32 v177, v224, v197
    v_fmac_f32 v184, v225, v196
    v_fmac_f32 v185, v225, v197
    v_lshlrev_b32 v196, 16, v153
    v_and_b32 v197, 0xffff0000, v153
    v_fmac_f32 v178, v224, v196
    v_fmac_f32 v179, v224, v197
    v_fmac_f32 v186, v225, v196
    v_fmac_f32 v187, v225, v197
    v_lshlrev_b32 v196, 16, v154
    v_and_b32 v197, 0xffff0000, v154
    v_fmac_f32 v180, v224, v196
    v_fmac_f32 v181, v224, v197
    v_fmac_f32 v188, v225, v196
    v_fmac_f32 v189, v225, v197
    v_lshlrev_b32 v196, 16, v155
    v_and_b32 v197, 0xffff0000, v155
    v_fmac_f32 v182, v224, v196
    v_fmac_f32 v183, v224, v197
    v_fmac_f32 v190, v225, v196
    v_fmac_f32 v191, v225, v197
    s_waitcnt vmcnt(2)
    v_lshlrev_b32 v196, 16, v156
    v_and_b32 v197, 0xffff0000, v156
    v_fmac_f32 v176, v226, v196
    v_fmac_f32 v177, v226, v197
    v_fmac_f32 v184, v227, v196
    v_fmac_f32 v185, v227, v197
    v_lshlrev_b32 v196, 16, v157
    v_and_b32 v197, 0xffff0000, v157
    v_fmac_f32 v178, v226, v196
    v_fmac_f32 v179, v226, v197
    v_fmac_f32 v186, v227, v196
    v_fmac_f32 v187, v227, v197
    v_lshlrev_b32 v196, 16, v158
    v_and_b32 v197, 0xffff0000, v158
    v_fmac_f32 v180, v226, v196
    v_fmac_f32 v181, v226, v197
    v_fmac_f32 v188, v227, v196
    v_fmac_f32 v189, v227, v197
    v_lshlrev_b32 v196, 16, v159
    v_and_b32 v197, 0xffff0000, v159
    v_fmac_f32 v182, v226, v196
    v_fmac_f32 v183, v226, v197
    v_fmac_f32 v190, v227, v196
    v_fmac_f32 v191, v227, v197
    s_waitcnt vmcnt(1)
    v_lshlrev_b32 v196, 16, v160
    v_and_b32 v197, 0xffff0000, v160
    v_fmac_f32 v176, v228, v196
    v_fmac_f32 v177, v228, v197
    v_fmac_f32 v184, v229, v196
    v_fmac_f32 v185, v229, v197
    v_lshlrev_b32 v196, 16, v161
    v_and_b32 v197, 0xffff0000, v161
    v_fmac_f32 v178, v228, v196
    v_fmac_f32 v179, v228, v197
    v_fmac_f32 v186, v229, v196
    v_fmac_f32 v187, v229, v197
    v_lshlrev_b32 v196, 16, v162
    v_and_b32 v197, 0xffff0000, v162
    v_fmac_f32 v180, v228, v196
    v_fmac_f32 v181, v228, v197
    v_fmac_f32 v188, v229, v196
    v_fmac_f32 v189, v229, v197
    v_lshlrev_b32 v196, 16, v163
    v_and_b32 v197, 0xffff0000, v163
    v_fmac_f32 v182, v228, v196
    v_fmac_f32 v183, v228, v197
    v_fmac_f32 v190, v229, v196
    v_fmac_f32 v191, v229, v197
    s_waitcnt vmcnt(0)
    v_lshlrev_b32 v196, 16, v164
    v_and_b32 v197, 0xffff0000, v164
    v_fmac_f32 v176, v230, v196
    v_fmac_f32 v177, v230, v197
    v_fmac_f32 v184, v231, v196
    v_fmac_f32 v185, v231, v197
    v_lshlrev_b32 v196, 16, v165
    v_and_b32 v197, 0xffff0000, v165
    v_fmac_f32 v178, v230, v196
    v_fmac_f32 v179, v230, v197
    v_fmac_f32 v186, v231, v196
    v_fmac_f32 v187, v231, v197
    v_lshlrev_b32 v196, 16, v166
    v_and_b32 v197, 0xffff0000, v166
    v_fmac_f32 v180, v230, v196
    v_fmac_f32 v181, v230, v197
    v_fmac_f32 v188, v231, v196
    v_fmac_f32 v189, v231, v197
    v_lshlrev_b32 v196, 16, v167
    v_and_b32 v197, 0xffff0000, v167
    v_fmac_f32 v182, v230, v196
    v_fmac_f32 v183, v230, v197
    v_fmac_f32 v190, v231, v196
    v_fmac_f32 v191, v231, v197
    v_lshrrev_b32 v195, 5, v1
    v_lshl_add_u32 v195, v2, 1, v195
    v_lshlrev_b32 v195, 11, v195
    v_and_b32 v196, 31, v1
    v_lshl_add_u32 v195, v196, 5, v195
    ds_write_b128 v195, v[176:179] offset:4096
    ds_write_b128 v195, v[180:183] offset:4112
    ds_write_b128 v195, v[184:187] offset:5120
    ds_write_b128 v195, v[188:191] offset:5136
    s_waitcnt lgkmcnt(0)
    s_barrier
    v_lshlrev_b32 v195, 2, v0
    ds_read_b32 v200, v195 offset:4096
    ds_read_b32 v201, v195 offset:6144
    ds_read_b32 v202, v195 offset:8192
    ds_read_b32 v203, v195 offset:10240
    ds_read_b32 v204, v195 offset:12288
    ds_read_b32 v205, v195 offset:14336
    ds_read_b32 v206, v195 offset:16384
    ds_read_b32 v207, v195 offset:18432
    ds_read_b32 v208, v195 offset:5120
    ds_read_b32 v209, v195 offset:7168
    ds_read_b32 v210, v195 offset:9216
    ds_read_b32 v211, v195 offset:11264
    ds_read_b32 v212, v195 offset:13312
    ds_read_b32 v213, v195 offset:15360
    ds_read_b32 v214, v195 offset:17408
    ds_read_b32 v215, v195 offset:19456
    v_and_b32 v196, 1, v0
    v_lshlrev_b32 v196, 2, v196
    ds_read_b32 v216, v196 offset:2048
    ds_read_b32 v217, v196 offset:2056
    ds_read_b32 v218, v196 offset:2064
    ds_read_b32 v219, v196 offset:2072
    ds_read_b32 v220, v196 offset:2080
    ds_read_b32 v221, v196 offset:2088
    ds_read_b32 v222, v196 offset:2096
    ds_read_b32 v223, v196 offset:2104
    ds_read_b32 v224, v196 offset:2112
    ds_read_b32 v225, v196 offset:2120
    ds_read_b32 v226, v196 offset:2128
    ds_read_b32 v227, v196 offset:2136
    ds_read_b32 v228, v196 offset:2144
    ds_read_b32 v229, v196 offset:2152
    ds_read_b32 v230, v196 offset:2160
    ds_read_b32 v231, v196 offset:2168
    s_waitcnt lgkmcnt(0)
    v_add_f32 v200, v200, v201
    v_add_f32 v200, v200, v202
    v_add_f32 v200, v200, v203
    v_add_f32 v200, v200, v204
    v_add_f32 v200, v200, v205
    v_add_f32 v200, v200, v206
    v_add_f32 v200, v200, v207
    v_add_f32 v208, v208, v209
    v_add_f32 v208, v208, v210
    v_add_f32 v208, v208, v211
    v_add_f32 v208, v208, v212
    v_add_f32 v208, v208, v213
    v_add_f32 v208, v208, v214
    v_add_f32 v208, v208, v215
    v_add_f32 v216, v216, v217
    v_add_f32 v216, v216, v218
    v_add_f32 v216, v216, v219
    v_add_f32 v216, v216, v220
    v_add_f32 v216, v216, v221
    v_add_f32 v216, v216, v222
    v_add_f32 v216, v216, v223
    v_add_f32 v216, v216, v224
    v_add_f32 v216, v216, v225
    v_add_f32 v216, v216, v226
    v_add_f32 v216, v216, v227
    v_add_f32 v216, v216, v228
    v_add_f32 v216, v216, v229
    v_add_f32 v216, v216, v230
    v_add_f32 v216, v216, v231
    s_lshl_b32 s20, s14, 6
    s_add_u32 s20, s20, s15
    s_lshl_b32 s21, s20, 10
    s_add_u32 s21, s21, 32768
    buffer_store_dword v200, v195, s[32:35], s21 offen
    s_add_u32 s21, s21, 32768
    buffer_store_dword v208, v195, s[32:35], s21 offen
    v_cmp_gt_u32 vcc, 2, v0
    s_and_saveexec_b64 s[40:41], vcc
    s_cbranch_execz K2_END
    v_lshlrev_b32 v195, 7, v0
    s_lshl_b32 s21, s20, 2
    s_add_u32 s22, s21, 24576
    s_add_u32 s23, s21, 28672
    buffer_store_dword v192, v195, s[32:35], s22 offen
    buffer_store_dword v216, v195, s[32:35], s23 offen
K2_END:
    s_endpgm
.globl k3_kernel
.p2align 8
.type k3_kernel,@function
k3_kernel:
    s_cmp_ge_u32 s2, 92
    s_cbranch_scc1 K3_END
    s_load_dwordx2 s[4:5], s[0:1], 0
    s_load_dwordx2 s[6:7], s[0:1], 32
    s_load_dwordx2 s[8:9], s[0:1], 64
    s_load_dwordx2 s[10:11], s[0:1], 72
    s_load_dwordx2 s[12:13], s[0:1], 88
    s_load_dwordx2 s[14:15], s[0:1], 80
    s_waitcnt lgkmcnt(0)
    s_cmp_lt_u32 s2, 64
    s_cselect_b32 s20, s6, s8
    s_cselect_b32 s21, s7, s9
    s_cselect_b32 s22, 0, 64
    s_sub_u32 s22, s2, s22
    s_mul_i32 s23, s22, 57344
    s_add_u32 s16, s20, s23
    s_addc_u32 s17, s21, 0
    s_and_b32 s17, s17, 0xffff
    s_mov_b32 s18, 57344
    s_mov_b32 s19, 0x00020000
    s_mov_b32 s24, s12
    s_and_b32 s25, s13, 0xffff
    s_mov_b32 s26, 0x100000
    s_mov_b32 s27, 0x00020000
    v_lshlrev_b32 v1, 4, v0
    s_mov_b32 s28, 0
    buffer_load_dwordx4 v[64:67], v1, s[16:19], s28 offen sc1 nt
    s_add_u32 s28, s28, 7168
    buffer_load_dwordx4 v[68:71], v1, s[16:19], s28 offen sc1 nt
    s_add_u32 s28, s28, 7168
    buffer_load_dwordx4 v[72:75], v1, s[16:19], s28 offen sc1 nt
    s_add_u32 s28, s28, 7168
    buffer_load_dwordx4 v[76:79], v1, s[16:19], s28 offen sc1 nt
    s_add_u32 s28, s28, 7168
    buffer_load_dwordx4 v[80:83], v1, s[16:19], s28 offen sc1 nt
    s_add_u32 s28, s28, 7168
    buffer_load_dwordx4 v[84:87], v1, s[16:19], s28 offen sc1 nt
    s_add_u32 s28, s28, 7168
    buffer_load_dwordx4 v[88:91], v1, s[16:19], s28 offen sc1 nt
    s_add_u32 s28, s28, 7168
    buffer_load_dwordx4 v[92:95], v1, s[16:19], s28 offen sc1 nt
    s_add_u32 s28, s28, 7168
    v_cmp_gt_u32 vcc, 64, v0
    s_and_saveexec_b64 s[40:41], vcc
    s_cbranch_execz K3_COEF_DONE
    s_cmp_lt_u32 s2, 64
    s_cbranch_scc0 K3_HCOEF
    s_lshr_b32 s29, s2, 2
    s_and_b32 s30, s2, 3
    s_lshl_b32 s31, s29, 7
    s_add_u32 s32, s31, 24576
    s_add_u32 s33, s31, 28672
    v_mov_b32 v2, 0
    s_lshl_b32 s34, s29, 15
    s_lshl_b32 s35, s30, 8
    s_add_u32 s34, s34, s35
    s_add_u32 s34, s34, 32768
    v_lshlrev_b32 v3, 2, v0
    buffer_load_dword v100, v2, s[24:27], s32 offen offset:0
    buffer_load_dword v132, v2, s[24:27], s33 offen offset:0
    buffer_load_dword v101, v2, s[24:27], s32 offen offset:4
    buffer_load_dword v133, v2, s[24:27], s33 offen offset:4
    buffer_load_dword v102, v2, s[24:27], s32 offen offset:8
    buffer_load_dword v134, v2, s[24:27], s33 offen offset:8
    buffer_load_dword v103, v2, s[24:27], s32 offen offset:12
    buffer_load_dword v135, v2, s[24:27], s33 offen offset:12
    buffer_load_dword v104, v2, s[24:27], s32 offen offset:16
    buffer_load_dword v136, v2, s[24:27], s33 offen offset:16
    buffer_load_dword v105, v2, s[24:27], s32 offen offset:20
    buffer_load_dword v137, v2, s[24:27], s33 offen offset:20
    buffer_load_dword v106, v2, s[24:27], s32 offen offset:24
    buffer_load_dword v138, v2, s[24:27], s33 offen offset:24
    buffer_load_dword v107, v2, s[24:27], s32 offen offset:28
    buffer_load_dword v139, v2, s[24:27], s33 offen offset:28
    buffer_load_dword v108, v2, s[24:27], s32 offen offset:32
    buffer_load_dword v140, v2, s[24:27], s33 offen offset:32
    buffer_load_dword v109, v2, s[24:27], s32 offen offset:36
    buffer_load_dword v141, v2, s[24:27], s33 offen offset:36
    buffer_load_dword v110, v2, s[24:27], s32 offen offset:40
    buffer_load_dword v142, v2, s[24:27], s33 offen offset:40
    buffer_load_dword v111, v2, s[24:27], s32 offen offset:44
    buffer_load_dword v143, v2, s[24:27], s33 offen offset:44
    buffer_load_dword v112, v2, s[24:27], s32 offen offset:48
    buffer_load_dword v144, v2, s[24:27], s33 offen offset:48
    buffer_load_dword v113, v2, s[24:27], s32 offen offset:52
    buffer_load_dword v145, v2, s[24:27], s33 offen offset:52
    buffer_load_dword v114, v2, s[24:27], s32 offen offset:56
    buffer_load_dword v146, v2, s[24:27], s33 offen offset:56
    buffer_load_dword v115, v2, s[24:27], s32 offen offset:60
    buffer_load_dword v147, v2, s[24:27], s33 offen offset:60
    buffer_load_dword v116, v2, s[24:27], s32 offen offset:64
    buffer_load_dword v148, v2, s[24:27], s33 offen offset:64
    buffer_load_dword v117, v2, s[24:27], s32 offen offset:68
    buffer_load_dword v149, v2, s[24:27], s33 offen offset:68
    buffer_load_dword v118, v2, s[24:27], s32 offen offset:72
    buffer_load_dword v150, v2, s[24:27], s33 offen offset:72
    buffer_load_dword v119, v2, s[24:27], s32 offen offset:76
    buffer_load_dword v151, v2, s[24:27], s33 offen offset:76
    buffer_load_dword v120, v2, s[24:27], s32 offen offset:80
    buffer_load_dword v152, v2, s[24:27], s33 offen offset:80
    buffer_load_dword v121, v2, s[24:27], s32 offen offset:84
    buffer_load_dword v153, v2, s[24:27], s33 offen offset:84
    buffer_load_dword v122, v2, s[24:27], s32 offen offset:88
    buffer_load_dword v154, v2, s[24:27], s33 offen offset:88
    buffer_load_dword v123, v2, s[24:27], s32 offen offset:92
    buffer_load_dword v155, v2, s[24:27], s33 offen offset:92
    buffer_load_dword v124, v2, s[24:27], s32 offen offset:96
    buffer_load_dword v156, v2, s[24:27], s33 offen offset:96
    buffer_load_dword v125, v2, s[24:27], s32 offen offset:100
    buffer_load_dword v157, v2, s[24:27], s33 offen offset:100
    buffer_load_dword v126, v2, s[24:27], s32 offen offset:104
    buffer_load_dword v158, v2, s[24:27], s33 offen offset:104
    buffer_load_dword v127, v2, s[24:27], s32 offen offset:108
    buffer_load_dword v159, v2, s[24:27], s33 offen offset:108
    buffer_load_dword v128, v2, s[24:27], s32 offen offset:112
    buffer_load_dword v160, v2, s[24:27], s33 offen offset:112
    buffer_load_dword v129, v2, s[24:27], s32 offen offset:116
    buffer_load_dword v161, v2, s[24:27], s33 offen offset:116
    buffer_load_dword v130, v2, s[24:27], s32 offen offset:120
    buffer_load_dword v162, v2, s[24:27], s33 offen offset:120
    buffer_load_dword v131, v2, s[24:27], s32 offen offset:124
    buffer_load_dword v163, v2, s[24:27], s33 offen offset:124
    s_waitcnt vmcnt(0)
    buffer_load_dword v164, v3, s[24:27], s34 offen
    s_add_u32 s34, s34, 1024
    buffer_load_dword v165, v3, s[24:27], s34 offen
    s_add_u32 s34, s34, 1024
    buffer_load_dword v166, v3, s[24:27], s34 offen
    s_add_u32 s34, s34, 1024
    buffer_load_dword v167, v3, s[24:27], s34 offen
    s_add_u32 s34, s34, 1024
    buffer_load_dword v168, v3, s[24:27], s34 offen
    s_add_u32 s34, s34, 1024
    buffer_load_dword v169, v3, s[24:27], s34 offen
    s_add_u32 s34, s34, 1024
    buffer_load_dword v170, v3, s[24:27], s34 offen
    s_add_u32 s34, s34, 1024
    buffer_load_dword v171, v3, s[24:27], s34 offen
    s_add_u32 s34, s34, 1024
    buffer_load_dword v172, v3, s[24:27], s34 offen
    s_add_u32 s34, s34, 1024
    buffer_load_dword v173, v3, s[24:27], s34 offen
    s_add_u32 s34, s34, 1024
    buffer_load_dword v174, v3, s[24:27], s34 offen
    s_add_u32 s34, s34, 1024
    buffer_load_dword v175, v3, s[24:27], s34 offen
    s_add_u32 s34, s34, 1024
    buffer_load_dword v176, v3, s[24:27], s34 offen
    s_add_u32 s34, s34, 1024
    buffer_load_dword v177, v3, s[24:27], s34 offen
    s_add_u32 s34, s34, 1024
    buffer_load_dword v178, v3, s[24:27], s34 offen
    s_add_u32 s34, s34, 1024
    buffer_load_dword v179, v3, s[24:27], s34 offen
    s_add_u32 s34, s34, 1024
    buffer_load_dword v180, v3, s[24:27], s34 offen
    s_add_u32 s34, s34, 1024
    buffer_load_dword v181, v3, s[24:27], s34 offen
    s_add_u32 s34, s34, 1024
    buffer_load_dword v182, v3, s[24:27], s34 offen
    s_add_u32 s34, s34, 1024
    buffer_load_dword v183, v3, s[24:27], s34 offen
    s_add_u32 s34, s34, 1024
    buffer_load_dword v184, v3, s[24:27], s34 offen
    s_add_u32 s34, s34, 1024
    buffer_load_dword v185, v3, s[24:27], s34 offen
    s_add_u32 s34, s34, 1024
    buffer_load_dword v186, v3, s[24:27], s34 offen
    s_add_u32 s34, s34, 1024
    buffer_load_dword v187, v3, s[24:27], s34 offen
    s_add_u32 s34, s34, 1024
    buffer_load_dword v188, v3, s[24:27], s34 offen
    s_add_u32 s34, s34, 1024
    buffer_load_dword v189, v3, s[24:27], s34 offen
    s_add_u32 s34, s34, 1024
    buffer_load_dword v190, v3, s[24:27], s34 offen
    s_add_u32 s34, s34, 1024
    buffer_load_dword v191, v3, s[24:27], s34 offen
    s_add_u32 s34, s34, 1024
    buffer_load_dword v192, v3, s[24:27], s34 offen
    s_add_u32 s34, s34, 1024
    buffer_load_dword v193, v3, s[24:27], s34 offen
    s_add_u32 s34, s34, 1024
    buffer_load_dword v194, v3, s[24:27], s34 offen
    s_add_u32 s34, s34, 1024
    buffer_load_dword v195, v3, s[24:27], s34 offen
    s_add_u32 s34, s34, 1024
    v_max_f32 v4, v100, v101
    v_max_f32 v4, v4, v102
    v_max_f32 v4, v4, v103
    v_max_f32 v4, v4, v104
    v_max_f32 v4, v4, v105
    v_max_f32 v4, v4, v106
    v_max_f32 v4, v4, v107
    v_max_f32 v4, v4, v108
    v_max_f32 v4, v4, v109
    v_max_f32 v4, v4, v110
    v_max_f32 v4, v4, v111
    v_max_f32 v4, v4, v112
    v_max_f32 v4, v4, v113
    v_max_f32 v4, v4, v114
    v_max_f32 v4, v4, v115
    v_max_f32 v4, v4, v116
    v_max_f32 v4, v4, v117
    v_max_f32 v4, v4, v118
    v_max_f32 v4, v4, v119
    v_max_f32 v4, v4, v120
    v_max_f32 v4, v4, v121
    v_max_f32 v4, v4, v122
    v_max_f32 v4, v4, v123
    v_max_f32 v4, v4, v124
    v_max_f32 v4, v4, v125
    v_max_f32 v4, v4, v126
    v_max_f32 v4, v4, v127
    v_max_f32 v4, v4, v128
    v_max_f32 v4, v4, v129
    v_max_f32 v4, v4, v130
    v_max_f32 v4, v4, v131
    v_mov_b32 v5, 0
    v_sub_f32 v100, v100, v4
    v_exp_f32 v100, v100
    s_nop 0
    v_fmac_f32 v5, v100, v132
    v_sub_f32 v101, v101, v4
    v_exp_f32 v101, v101
    s_nop 0
    v_fmac_f32 v5, v101, v133
    v_sub_f32 v102, v102, v4
    v_exp_f32 v102, v102
    s_nop 0
    v_fmac_f32 v5, v102, v134
    v_sub_f32 v103, v103, v4
    v_exp_f32 v103, v103
    s_nop 0
    v_fmac_f32 v5, v103, v135
    v_sub_f32 v104, v104, v4
    v_exp_f32 v104, v104
    s_nop 0
    v_fmac_f32 v5, v104, v136
    v_sub_f32 v105, v105, v4
    v_exp_f32 v105, v105
    s_nop 0
    v_fmac_f32 v5, v105, v137
    v_sub_f32 v106, v106, v4
    v_exp_f32 v106, v106
    s_nop 0
    v_fmac_f32 v5, v106, v138
    v_sub_f32 v107, v107, v4
    v_exp_f32 v107, v107
    s_nop 0
    v_fmac_f32 v5, v107, v139
    v_sub_f32 v108, v108, v4
    v_exp_f32 v108, v108
    s_nop 0
    v_fmac_f32 v5, v108, v140
    v_sub_f32 v109, v109, v4
    v_exp_f32 v109, v109
    s_nop 0
    v_fmac_f32 v5, v109, v141
    v_sub_f32 v110, v110, v4
    v_exp_f32 v110, v110
    s_nop 0
    v_fmac_f32 v5, v110, v142
    v_sub_f32 v111, v111, v4
    v_exp_f32 v111, v111
    s_nop 0
    v_fmac_f32 v5, v111, v143
    v_sub_f32 v112, v112, v4
    v_exp_f32 v112, v112
    s_nop 0
    v_fmac_f32 v5, v112, v144
    v_sub_f32 v113, v113, v4
    v_exp_f32 v113, v113
    s_nop 0
    v_fmac_f32 v5, v113, v145
    v_sub_f32 v114, v114, v4
    v_exp_f32 v114, v114
    s_nop 0
    v_fmac_f32 v5, v114, v146
    v_sub_f32 v115, v115, v4
    v_exp_f32 v115, v115
    s_nop 0
    v_fmac_f32 v5, v115, v147
    v_sub_f32 v116, v116, v4
    v_exp_f32 v116, v116
    s_nop 0
    v_fmac_f32 v5, v116, v148
    v_sub_f32 v117, v117, v4
    v_exp_f32 v117, v117
    s_nop 0
    v_fmac_f32 v5, v117, v149
    v_sub_f32 v118, v118, v4
    v_exp_f32 v118, v118
    s_nop 0
    v_fmac_f32 v5, v118, v150
    v_sub_f32 v119, v119, v4
    v_exp_f32 v119, v119
    s_nop 0
    v_fmac_f32 v5, v119, v151
    v_sub_f32 v120, v120, v4
    v_exp_f32 v120, v120
    s_nop 0
    v_fmac_f32 v5, v120, v152
    v_sub_f32 v121, v121, v4
    v_exp_f32 v121, v121
    s_nop 0
    v_fmac_f32 v5, v121, v153
    v_sub_f32 v122, v122, v4
    v_exp_f32 v122, v122
    s_nop 0
    v_fmac_f32 v5, v122, v154
    v_sub_f32 v123, v123, v4
    v_exp_f32 v123, v123
    s_nop 0
    v_fmac_f32 v5, v123, v155
    v_sub_f32 v124, v124, v4
    v_exp_f32 v124, v124
    s_nop 0
    v_fmac_f32 v5, v124, v156
    v_sub_f32 v125, v125, v4
    v_exp_f32 v125, v125
    s_nop 0
    v_fmac_f32 v5, v125, v157
    v_sub_f32 v126, v126, v4
    v_exp_f32 v126, v126
    s_nop 0
    v_fmac_f32 v5, v126, v158
    v_sub_f32 v127, v127, v4
    v_exp_f32 v127, v127
    s_nop 0
    v_fmac_f32 v5, v127, v159
    v_sub_f32 v128, v128, v4
    v_exp_f32 v128, v128
    s_nop 0
    v_fmac_f32 v5, v128, v160
    v_sub_f32 v129, v129, v4
    v_exp_f32 v129, v129
    s_nop 0
    v_fmac_f32 v5, v129, v161
    v_sub_f32 v130, v130, v4
    v_exp_f32 v130, v130
    s_nop 0
    v_fmac_f32 v5, v130, v162
    v_sub_f32 v131, v131, v4
    v_exp_f32 v131, v131
    s_nop 0
    v_fmac_f32 v5, v131, v163
    v_mov_b32 v6, 0
    s_waitcnt vmcnt(0)
    v_fmac_f32 v6, v100, v164
    v_fmac_f32 v6, v101, v165
    v_fmac_f32 v6, v102, v166
    v_fmac_f32 v6, v103, v167
    v_fmac_f32 v6, v104, v168
    v_fmac_f32 v6, v105, v169
    v_fmac_f32 v6, v106, v170
    v_fmac_f32 v6, v107, v171
    v_fmac_f32 v6, v108, v172
    v_fmac_f32 v6, v109, v173
    v_fmac_f32 v6, v110, v174
    v_fmac_f32 v6, v111, v175
    v_fmac_f32 v6, v112, v176
    v_fmac_f32 v6, v113, v177
    v_fmac_f32 v6, v114, v178
    v_fmac_f32 v6, v115, v179
    v_fmac_f32 v6, v116, v180
    v_fmac_f32 v6, v117, v181
    v_fmac_f32 v6, v118, v182
    v_fmac_f32 v6, v119, v183
    v_fmac_f32 v6, v120, v184
    v_fmac_f32 v6, v121, v185
    v_fmac_f32 v6, v122, v186
    v_fmac_f32 v6, v123, v187
    v_fmac_f32 v6, v124, v188
    v_fmac_f32 v6, v125, v189
    v_fmac_f32 v6, v126, v190
    v_fmac_f32 v6, v127, v191
    v_fmac_f32 v6, v128, v192
    v_fmac_f32 v6, v129, v193
    v_fmac_f32 v6, v130, v194
    v_fmac_f32 v6, v131, v195
    v_rcp_f32 v5, v5
    s_nop 0
    v_mul_f32 v6, v6, v5
    v_cvt_pk_bf16_f32 v7, v6, v6
    v_lshlrev_b32 v6, 16, v7
    s_branch K3_COEF_ST
K3_HCOEF:
    s_sub_u32 s29, s2, 64
    s_lshl_b32 s29, s29, 8
    s_add_u32 s30, s29, 8192
    s_add_u32 s31, s29, 16384
    v_lshlrev_b32 v3, 2, v0
    buffer_load_dword v4, v3, s[24:27], s30 offen
    buffer_load_dword v5, v3, s[24:27], s31 offen
    s_waitcnt vmcnt(0)
    v_mul_f32 v4, 0xbfb8aa3b, v4
    v_exp_f32 v4, v4
    s_nop 0
    v_add_f32 v4, 1.0, v4
    v_rcp_f32 v4, v4
    s_nop 0
    v_cvt_pk_bf16_f32 v7, v4, v4
    v_lshlrev_b32 v4, 16, v7
    v_mul_f32 v6, v4, v5
    v_cvt_pk_bf16_f32 v7, v6, v6
    v_lshlrev_b32 v6, 16, v7
K3_COEF_ST:
    v_lshlrev_b32 v3, 2, v0
    ds_write_b32 v3, v6
K3_COEF_DONE:
    s_mov_b64 exec, s[40:41]
    s_waitcnt lgkmcnt(0)
    s_barrier
    v_mul_u32_u24 v2, 1171, v0
    v_lshrrev_b32 v2, 16, v2
    v_lshlrev_b32 v3, 2, v2
    ds_read_b32 v8, v3 offset:0
    ds_read_b32 v9, v3 offset:32
    ds_read_b32 v10, v3 offset:64
    ds_read_b32 v11, v3 offset:96
    ds_read_b32 v12, v3 offset:128
    ds_read_b32 v13, v3 offset:160
    ds_read_b32 v14, v3 offset:192
    ds_read_b32 v15, v3 offset:224
    v_mov_b32 v16, 0
    v_mov_b32 v17, 0
    v_mov_b32 v18, 0
    v_mov_b32 v19, 0
    v_mov_b32 v20, 0
    v_mov_b32 v21, 0
    v_mov_b32 v22, 0
    v_mov_b32 v23, 0
    s_waitcnt lgkmcnt(0)
    s_waitcnt vmcnt(0)
    v_lshlrev_b32 v24, 16, v64
    v_and_b32 v25, 0xffff0000, v64
    v_fmac_f32 v16, v8, v24
    v_fmac_f32 v17, v8, v25
    v_lshlrev_b32 v24, 16, v65
    v_and_b32 v25, 0xffff0000, v65
    v_fmac_f32 v18, v8, v24
    v_fmac_f32 v19, v8, v25
    v_lshlrev_b32 v24, 16, v66
    v_and_b32 v25, 0xffff0000, v66
    v_fmac_f32 v20, v8, v24
    v_fmac_f32 v21, v8, v25
    v_lshlrev_b32 v24, 16, v67
    v_and_b32 v25, 0xffff0000, v67
    v_fmac_f32 v22, v8, v24
    v_fmac_f32 v23, v8, v25
    v_lshlrev_b32 v24, 16, v68
    v_and_b32 v25, 0xffff0000, v68
    v_fmac_f32 v16, v9, v24
    v_fmac_f32 v17, v9, v25
    v_lshlrev_b32 v24, 16, v69
    v_and_b32 v25, 0xffff0000, v69
    v_fmac_f32 v18, v9, v24
    v_fmac_f32 v19, v9, v25
    v_lshlrev_b32 v24, 16, v70
    v_and_b32 v25, 0xffff0000, v70
    v_fmac_f32 v20, v9, v24
    v_fmac_f32 v21, v9, v25
    v_lshlrev_b32 v24, 16, v71
    v_and_b32 v25, 0xffff0000, v71
    v_fmac_f32 v22, v9, v24
    v_fmac_f32 v23, v9, v25
    v_lshlrev_b32 v24, 16, v72
    v_and_b32 v25, 0xffff0000, v72
    v_fmac_f32 v16, v10, v24
    v_fmac_f32 v17, v10, v25
    v_lshlrev_b32 v24, 16, v73
    v_and_b32 v25, 0xffff0000, v73
    v_fmac_f32 v18, v10, v24
    v_fmac_f32 v19, v10, v25
    v_lshlrev_b32 v24, 16, v74
    v_and_b32 v25, 0xffff0000, v74
    v_fmac_f32 v20, v10, v24
    v_fmac_f32 v21, v10, v25
    v_lshlrev_b32 v24, 16, v75
    v_and_b32 v25, 0xffff0000, v75
    v_fmac_f32 v22, v10, v24
    v_fmac_f32 v23, v10, v25
    v_lshlrev_b32 v24, 16, v76
    v_and_b32 v25, 0xffff0000, v76
    v_fmac_f32 v16, v11, v24
    v_fmac_f32 v17, v11, v25
    v_lshlrev_b32 v24, 16, v77
    v_and_b32 v25, 0xffff0000, v77
    v_fmac_f32 v18, v11, v24
    v_fmac_f32 v19, v11, v25
    v_lshlrev_b32 v24, 16, v78
    v_and_b32 v25, 0xffff0000, v78
    v_fmac_f32 v20, v11, v24
    v_fmac_f32 v21, v11, v25
    v_lshlrev_b32 v24, 16, v79
    v_and_b32 v25, 0xffff0000, v79
    v_fmac_f32 v22, v11, v24
    v_fmac_f32 v23, v11, v25
    v_lshlrev_b32 v24, 16, v80
    v_and_b32 v25, 0xffff0000, v80
    v_fmac_f32 v16, v12, v24
    v_fmac_f32 v17, v12, v25
    v_lshlrev_b32 v24, 16, v81
    v_and_b32 v25, 0xffff0000, v81
    v_fmac_f32 v18, v12, v24
    v_fmac_f32 v19, v12, v25
    v_lshlrev_b32 v24, 16, v82
    v_and_b32 v25, 0xffff0000, v82
    v_fmac_f32 v20, v12, v24
    v_fmac_f32 v21, v12, v25
    v_lshlrev_b32 v24, 16, v83
    v_and_b32 v25, 0xffff0000, v83
    v_fmac_f32 v22, v12, v24
    v_fmac_f32 v23, v12, v25
    v_lshlrev_b32 v24, 16, v84
    v_and_b32 v25, 0xffff0000, v84
    v_fmac_f32 v16, v13, v24
    v_fmac_f32 v17, v13, v25
    v_lshlrev_b32 v24, 16, v85
    v_and_b32 v25, 0xffff0000, v85
    v_fmac_f32 v18, v13, v24
    v_fmac_f32 v19, v13, v25
    v_lshlrev_b32 v24, 16, v86
    v_and_b32 v25, 0xffff0000, v86
    v_fmac_f32 v20, v13, v24
    v_fmac_f32 v21, v13, v25
    v_lshlrev_b32 v24, 16, v87
    v_and_b32 v25, 0xffff0000, v87
    v_fmac_f32 v22, v13, v24
    v_fmac_f32 v23, v13, v25
    v_lshlrev_b32 v24, 16, v88
    v_and_b32 v25, 0xffff0000, v88
    v_fmac_f32 v16, v14, v24
    v_fmac_f32 v17, v14, v25
    v_lshlrev_b32 v24, 16, v89
    v_and_b32 v25, 0xffff0000, v89
    v_fmac_f32 v18, v14, v24
    v_fmac_f32 v19, v14, v25
    v_lshlrev_b32 v24, 16, v90
    v_and_b32 v25, 0xffff0000, v90
    v_fmac_f32 v20, v14, v24
    v_fmac_f32 v21, v14, v25
    v_lshlrev_b32 v24, 16, v91
    v_and_b32 v25, 0xffff0000, v91
    v_fmac_f32 v22, v14, v24
    v_fmac_f32 v23, v14, v25
    v_lshlrev_b32 v24, 16, v92
    v_and_b32 v25, 0xffff0000, v92
    v_fmac_f32 v16, v15, v24
    v_fmac_f32 v17, v15, v25
    v_lshlrev_b32 v24, 16, v93
    v_and_b32 v25, 0xffff0000, v93
    v_fmac_f32 v18, v15, v24
    v_fmac_f32 v19, v15, v25
    v_lshlrev_b32 v24, 16, v94
    v_and_b32 v25, 0xffff0000, v94
    v_fmac_f32 v20, v15, v24
    v_fmac_f32 v21, v15, v25
    v_lshlrev_b32 v24, 16, v95
    v_and_b32 v25, 0xffff0000, v95
    v_fmac_f32 v22, v15, v24
    v_fmac_f32 v23, v15, v25
    v_lshlrev_b32 v3, 5, v0
    ds_write_b128 v3, v[16:19] offset:1024
    ds_write_b128 v3, v[20:23] offset:1040
    s_waitcnt lgkmcnt(0)
    s_barrier
    v_lshlrev_b32 v3, 2, v0
    ds_read_b32 v8, v3 offset:1024
    ds_read_b32 v9, v3 offset:2816
    ds_read_b32 v10, v3 offset:4608
    ds_read_b32 v11, v3 offset:6400
    ds_read_b32 v12, v3 offset:8192
    ds_read_b32 v13, v3 offset:9984
    ds_read_b32 v14, v3 offset:11776
    ds_read_b32 v15, v3 offset:13568
    s_waitcnt lgkmcnt(0)
    v_add_f32 v8, v8, v9
    v_add_f32 v8, v8, v10
    v_add_f32 v8, v8, v11
    v_add_f32 v8, v8, v12
    v_add_f32 v8, v8, v13
    v_add_f32 v8, v8, v14
    v_add_f32 v8, v8, v15
    s_mul_i32 s28, s2, 1792
    s_add_u32 s28, s28, 557056
    buffer_store_dword v8, v3, s[24:27], s28 offen sc1
    s_waitcnt vmcnt(0)
    s_barrier
    v_cmp_eq_u32 vcc, 0, v0
    s_and_saveexec_b64 s[40:41], vcc
    v_mov_b32 v4, 0
    v_mov_b32 v5, 1
    global_atomic_add v6, v4, v5, s[14:15] sc0
    s_waitcnt vmcnt(0)
    v_mov_b32 v4, 0
    ds_write_b32 v4, v6 offset:16384
    s_mov_b64 exec, s[40:41]
    s_waitcnt lgkmcnt(0)
    s_barrier
    v_mov_b32 v4, 0
    ds_read_b32 v6, v4 offset:16384
    s_waitcnt lgkmcnt(0)
    v_readfirstlane_b32 s29, v6
    s_cmp_eq_u32 s29, 91
    s_cbranch_scc0 K3_END
    s_mov_b32 s28, 557056
    buffer_load_dword v64, v3, s[24:27], s28 offen sc1
    s_add_u32 s28, s28, 1792
    buffer_load_dword v65, v3, s[24:27], s28 offen sc1
    s_add_u32 s28, s28, 1792
    buffer_load_dword v66, v3, s[24:27], s28 offen sc1
    s_add_u32 s28, s28, 1792
    buffer_load_dword v67, v3, s[24:27], s28 offen sc1
    s_add_u32 s28, s28, 1792
    buffer_load_dword v68, v3, s[24:27], s28 offen sc1
    s_add_u32 s28, s28, 1792
    buffer_load_dword v69, v3, s[24:27], s28 offen sc1
    s_add_u32 s28, s28, 1792
    buffer_load_dword v70, v3, s[24:27], s28 offen sc1
    s_add_u32 s28, s28, 1792
    buffer_load_dword v71, v3, s[24:27], s28 offen sc1
    s_add_u32 s28, s28, 1792
    buffer_load_dword v72, v3, s[24:27], s28 offen sc1
    s_add_u32 s28, s28, 1792
    buffer_load_dword v73, v3, s[24:27], s28 offen sc1
    s_add_u32 s28, s28, 1792
    buffer_load_dword v74, v3, s[24:27], s28 offen sc1
    s_add_u32 s28, s28, 1792
    buffer_load_dword v75, v3, s[24:27], s28 offen sc1
    s_add_u32 s28, s28, 1792
    buffer_load_dword v76, v3, s[24:27], s28 offen sc1
    s_add_u32 s28, s28, 1792
    buffer_load_dword v77, v3, s[24:27], s28 offen sc1
    s_add_u32 s28, s28, 1792
    buffer_load_dword v78, v3, s[24:27], s28 offen sc1
    s_add_u32 s28, s28, 1792
    buffer_load_dword v79, v3, s[24:27], s28 offen sc1
    s_add_u32 s28, s28, 1792
    buffer_load_dword v80, v3, s[24:27], s28 offen sc1
    s_add_u32 s28, s28, 1792
    buffer_load_dword v81, v3, s[24:27], s28 offen sc1
    s_add_u32 s28, s28, 1792
    buffer_load_dword v82, v3, s[24:27], s28 offen sc1
    s_add_u32 s28, s28, 1792
    buffer_load_dword v83, v3, s[24:27], s28 offen sc1
    s_add_u32 s28, s28, 1792
    buffer_load_dword v84, v3, s[24:27], s28 offen sc1
    s_add_u32 s28, s28, 1792
    buffer_load_dword v85, v3, s[24:27], s28 offen sc1
    s_add_u32 s28, s28, 1792
    buffer_load_dword v86, v3, s[24:27], s28 offen sc1
    s_add_u32 s28, s28, 1792
    buffer_load_dword v87, v3, s[24:27], s28 offen sc1
    s_add_u32 s28, s28, 1792
    buffer_load_dword v88, v3, s[24:27], s28 offen sc1
    s_add_u32 s28, s28, 1792
    buffer_load_dword v89, v3, s[24:27], s28 offen sc1
    s_add_u32 s28, s28, 1792
    buffer_load_dword v90, v3, s[24:27], s28 offen sc1
    s_add_u32 s28, s28, 1792
    buffer_load_dword v91, v3, s[24:27], s28 offen sc1
    s_add_u32 s28, s28, 1792
    buffer_load_dword v92, v3, s[24:27], s28 offen sc1
    s_add_u32 s28, s28, 1792
    buffer_load_dword v93, v3, s[24:27], s28 offen sc1
    s_add_u32 s28, s28, 1792
    buffer_load_dword v94, v3, s[24:27], s28 offen sc1
    s_add_u32 s28, s28, 1792
    buffer_load_dword v95, v3, s[24:27], s28 offen sc1
    s_add_u32 s28, s28, 1792
    buffer_load_dword v96, v3, s[24:27], s28 offen sc1
    s_add_u32 s28, s28, 1792
    buffer_load_dword v97, v3, s[24:27], s28 offen sc1
    s_add_u32 s28, s28, 1792
    buffer_load_dword v98, v3, s[24:27], s28 offen sc1
    s_add_u32 s28, s28, 1792
    buffer_load_dword v99, v3, s[24:27], s28 offen sc1
    s_add_u32 s28, s28, 1792
    buffer_load_dword v100, v3, s[24:27], s28 offen sc1
    s_add_u32 s28, s28, 1792
    buffer_load_dword v101, v3, s[24:27], s28 offen sc1
    s_add_u32 s28, s28, 1792
    buffer_load_dword v102, v3, s[24:27], s28 offen sc1
    s_add_u32 s28, s28, 1792
    buffer_load_dword v103, v3, s[24:27], s28 offen sc1
    s_add_u32 s28, s28, 1792
    buffer_load_dword v104, v3, s[24:27], s28 offen sc1
    s_add_u32 s28, s28, 1792
    buffer_load_dword v105, v3, s[24:27], s28 offen sc1
    s_add_u32 s28, s28, 1792
    buffer_load_dword v106, v3, s[24:27], s28 offen sc1
    s_add_u32 s28, s28, 1792
    buffer_load_dword v107, v3, s[24:27], s28 offen sc1
    s_add_u32 s28, s28, 1792
    buffer_load_dword v108, v3, s[24:27], s28 offen sc1
    s_add_u32 s28, s28, 1792
    buffer_load_dword v109, v3, s[24:27], s28 offen sc1
    s_add_u32 s28, s28, 1792
    buffer_load_dword v110, v3, s[24:27], s28 offen sc1
    s_add_u32 s28, s28, 1792
    buffer_load_dword v111, v3, s[24:27], s28 offen sc1
    s_add_u32 s28, s28, 1792
    buffer_load_dword v112, v3, s[24:27], s28 offen sc1
    s_add_u32 s28, s28, 1792
    buffer_load_dword v113, v3, s[24:27], s28 offen sc1
    s_add_u32 s28, s28, 1792
    buffer_load_dword v114, v3, s[24:27], s28 offen sc1
    s_add_u32 s28, s28, 1792
    buffer_load_dword v115, v3, s[24:27], s28 offen sc1
    s_add_u32 s28, s28, 1792
    buffer_load_dword v116, v3, s[24:27], s28 offen sc1
    s_add_u32 s28, s28, 1792
    buffer_load_dword v117, v3, s[24:27], s28 offen sc1
    s_add_u32 s28, s28, 1792
    buffer_load_dword v118, v3, s[24:27], s28 offen sc1
    s_add_u32 s28, s28, 1792
    buffer_load_dword v119, v3, s[24:27], s28 offen sc1
    s_add_u32 s28, s28, 1792
    buffer_load_dword v120, v3, s[24:27], s28 offen sc1
    s_add_u32 s28, s28, 1792
    buffer_load_dword v121, v3, s[24:27], s28 offen sc1
    s_add_u32 s28, s28, 1792
    buffer_load_dword v122, v3, s[24:27], s28 offen sc1
    s_add_u32 s28, s28, 1792
    buffer_load_dword v123, v3, s[24:27], s28 offen sc1
    s_add_u32 s28, s28, 1792
    buffer_load_dword v124, v3, s[24:27], s28 offen sc1
    s_add_u32 s28, s28, 1792
    buffer_load_dword v125, v3, s[24:27], s28 offen sc1
    s_add_u32 s28, s28, 1792
    buffer_load_dword v126, v3, s[24:27], s28 offen sc1
    s_add_u32 s28, s28, 1792
    buffer_load_dword v127, v3, s[24:27], s28 offen sc1
    s_add_u32 s28, s28, 1792
    buffer_load_dword v128, v3, s[24:27], s28 offen sc1
    s_add_u32 s28, s28, 1792
    buffer_load_dword v129, v3, s[24:27], s28 offen sc1
    s_add_u32 s28, s28, 1792
    buffer_load_dword v130, v3, s[24:27], s28 offen sc1
    s_add_u32 s28, s28, 1792
    buffer_load_dword v131, v3, s[24:27], s28 offen sc1
    s_add_u32 s28, s28, 1792
    buffer_load_dword v132, v3, s[24:27], s28 offen sc1
    s_add_u32 s28, s28, 1792
    buffer_load_dword v133, v3, s[24:27], s28 offen sc1
    s_add_u32 s28, s28, 1792
    buffer_load_dword v134, v3, s[24:27], s28 offen sc1
    s_add_u32 s28, s28, 1792
    buffer_load_dword v135, v3, s[24:27], s28 offen sc1
    s_add_u32 s28, s28, 1792
    buffer_load_dword v136, v3, s[24:27], s28 offen sc1
    s_add_u32 s28, s28, 1792
    buffer_load_dword v137, v3, s[24:27], s28 offen sc1
    s_add_u32 s28, s28, 1792
    buffer_load_dword v138, v3, s[24:27], s28 offen sc1
    s_add_u32 s28, s28, 1792
    buffer_load_dword v139, v3, s[24:27], s28 offen sc1
    s_add_u32 s28, s28, 1792
    buffer_load_dword v140, v3, s[24:27], s28 offen sc1
    s_add_u32 s28, s28, 1792
    buffer_load_dword v141, v3, s[24:27], s28 offen sc1
    s_add_u32 s28, s28, 1792
    buffer_load_dword v142, v3, s[24:27], s28 offen sc1
    s_add_u32 s28, s28, 1792
    buffer_load_dword v143, v3, s[24:27], s28 offen sc1
    s_add_u32 s28, s28, 1792
    buffer_load_dword v144, v3, s[24:27], s28 offen sc1
    s_add_u32 s28, s28, 1792
    buffer_load_dword v145, v3, s[24:27], s28 offen sc1
    s_add_u32 s28, s28, 1792
    buffer_load_dword v146, v3, s[24:27], s28 offen sc1
    s_add_u32 s28, s28, 1792
    buffer_load_dword v147, v3, s[24:27], s28 offen sc1
    s_add_u32 s28, s28, 1792
    buffer_load_dword v148, v3, s[24:27], s28 offen sc1
    s_add_u32 s28, s28, 1792
    buffer_load_dword v149, v3, s[24:27], s28 offen sc1
    s_add_u32 s28, s28, 1792
    buffer_load_dword v150, v3, s[24:27], s28 offen sc1
    s_add_u32 s28, s28, 1792
    buffer_load_dword v151, v3, s[24:27], s28 offen sc1
    s_add_u32 s28, s28, 1792
    buffer_load_dword v152, v3, s[24:27], s28 offen sc1
    s_add_u32 s28, s28, 1792
    buffer_load_dword v153, v3, s[24:27], s28 offen sc1
    s_add_u32 s28, s28, 1792
    buffer_load_dword v154, v3, s[24:27], s28 offen sc1
    s_add_u32 s28, s28, 1792
    buffer_load_dword v155, v3, s[24:27], s28 offen sc1
    s_add_u32 s28, s28, 1792
    s_mov_b32 s32, s4
    s_and_b32 s33, s5, 0xffff
    s_movk_i32 s34, 896
    s_mov_b32 s35, 0x00020000
    v_lshlrev_b32 v4, 1, v0
    buffer_load_ushort v5, v4, s[32:35], 0 offen
    s_waitcnt vmcnt(0)
    v_lshlrev_b32 v5, 16, v5
    v_add_f32 v64, v64, v65
    v_add_f32 v64, v64, v66
    v_add_f32 v64, v64, v67
    v_add_f32 v64, v64, v68
    v_add_f32 v64, v64, v69
    v_add_f32 v64, v64, v70
    v_add_f32 v64, v64, v71
    v_add_f32 v64, v64, v72
    v_add_f32 v64, v64, v73
    v_add_f32 v64, v64, v74
    v_add_f32 v64, v64, v75
    v_add_f32 v64, v64, v76
    v_add_f32 v64, v64, v77
    v_add_f32 v64, v64, v78
    v_add_f32 v64, v64, v79
    v_add_f32 v64, v64, v80
    v_add_f32 v64, v64, v81
    v_add_f32 v64, v64, v82
    v_add_f32 v64, v64, v83
    v_add_f32 v64, v64, v84
    v_add_f32 v64, v64, v85
    v_add_f32 v64, v64, v86
    v_add_f32 v64, v64, v87
    v_add_f32 v64, v64, v88
    v_add_f32 v64, v64, v89
    v_add_f32 v64, v64, v90
    v_add_f32 v64, v64, v91
    v_add_f32 v64, v64, v92
    v_add_f32 v64, v64, v93
    v_add_f32 v64, v64, v94
    v_add_f32 v64, v64, v95
    v_add_f32 v64, v64, v96
    v_add_f32 v64, v64, v97
    v_add_f32 v64, v64, v98
    v_add_f32 v64, v64, v99
    v_add_f32 v64, v64, v100
    v_add_f32 v64, v64, v101
    v_add_f32 v64, v64, v102
    v_add_f32 v64, v64, v103
    v_add_f32 v64, v64, v104
    v_add_f32 v64, v64, v105
    v_add_f32 v64, v64, v106
    v_add_f32 v64, v64, v107
    v_add_f32 v64, v64, v108
    v_add_f32 v64, v64, v109
    v_add_f32 v64, v64, v110
    v_add_f32 v64, v64, v111
    v_add_f32 v64, v64, v112
    v_add_f32 v64, v64, v113
    v_add_f32 v64, v64, v114
    v_add_f32 v64, v64, v115
    v_add_f32 v64, v64, v116
    v_add_f32 v64, v64, v117
    v_add_f32 v64, v64, v118
    v_add_f32 v64, v64, v119
    v_add_f32 v64, v64, v120
    v_add_f32 v64, v64, v121
    v_add_f32 v64, v64, v122
    v_add_f32 v64, v64, v123
    v_add_f32 v64, v64, v124
    v_add_f32 v64, v64, v125
    v_add_f32 v64, v64, v126
    v_add_f32 v64, v64, v127
    v_add_f32 v128, v128, v129
    v_add_f32 v128, v128, v130
    v_add_f32 v128, v128, v131
    v_add_f32 v128, v128, v132
    v_add_f32 v128, v128, v133
    v_add_f32 v128, v128, v134
    v_add_f32 v128, v128, v135
    v_add_f32 v128, v128, v136
    v_add_f32 v128, v128, v137
    v_add_f32 v128, v128, v138
    v_add_f32 v128, v128, v139
    v_add_f32 v128, v128, v140
    v_add_f32 v128, v128, v141
    v_add_f32 v128, v128, v142
    v_add_f32 v128, v128, v143
    v_add_f32 v128, v128, v144
    v_add_f32 v128, v128, v145
    v_add_f32 v128, v128, v146
    v_add_f32 v128, v128, v147
    v_add_f32 v128, v128, v148
    v_add_f32 v128, v128, v149
    v_add_f32 v128, v128, v150
    v_add_f32 v128, v128, v151
    v_add_f32 v128, v128, v152
    v_add_f32 v128, v128, v153
    v_add_f32 v128, v128, v154
    v_add_f32 v128, v128, v155
    v_cvt_pk_bf16_f32 v7, v64, v64
    v_lshlrev_b32 v64, 16, v7
    v_cvt_pk_bf16_f32 v7, v128, v128
    v_lshlrev_b32 v128, 16, v7
    v_add_f32 v5, v5, v64
    v_cvt_pk_bf16_f32 v7, v5, v5
    v_lshlrev_b32 v5, 16, v7
    v_add_f32 v5, v5, v128
    v_cvt_pk_bf16_f32 v5, v5, v5
    s_mov_b32 s32, s10
    s_and_b32 s33, s11, 0xffff
    s_movk_i32 s34, 896
    s_mov_b32 s35, 0x00020000
    buffer_store_short v5, v4, s[32:35], 0 offen
K3_END:
    s_endpgm
.section .rodata,"a"
.p2align 6
.amdhsa_kernel k1_kernel
  .amdhsa_next_free_vgpr 128
  .amdhsa_next_free_sgpr 64
  .amdhsa_accum_offset 128
  .amdhsa_group_segment_fixed_size 0
  .amdhsa_kernarg_size 96
  .amdhsa_user_sgpr_count 2
  .amdhsa_user_sgpr_kernarg_segment_ptr 1
  .amdhsa_system_sgpr_workgroup_id_x 1
.end_amdhsa_kernel
.p2align 6
.amdhsa_kernel k2_kernel
  .amdhsa_next_free_vgpr 240
  .amdhsa_next_free_sgpr 64
  .amdhsa_accum_offset 240
  .amdhsa_group_segment_fixed_size 0
  .amdhsa_kernarg_size 96
  .amdhsa_user_sgpr_count 2
  .amdhsa_user_sgpr_kernarg_segment_ptr 1
  .amdhsa_system_sgpr_workgroup_id_x 1
.end_amdhsa_kernel
.p2align 6
.amdhsa_kernel k3_kernel
  .amdhsa_next_free_vgpr 200
  .amdhsa_next_free_sgpr 64
  .amdhsa_accum_offset 200
  .amdhsa_group_segment_fixed_size 0
  .amdhsa_kernarg_size 96
  .amdhsa_user_sgpr_count 2
  .amdhsa_user_sgpr_kernarg_segment_ptr 1
  .amdhsa_system_sgpr_workgroup_id_x 1
.end_amdhsa_kernel
```
